```python
import torch

def _softmax(x, axis=-1):
    return torch.softmax(x, dim=axis)
def _gelu(x):
    return torch.nn.functional.gelu(x, approximate="tanh")
def _silu(x):
    return torch.nn.functional.silu(x)
def _sigmoid(x):
    return torch.sigmoid(x)
def _layernorm(x, axis=-1, eps=1e-5):
    m = x.mean(dim=axis, keepdim=True)
    v = x.var(dim=axis, keepdim=True, unbiased=False)
    return (x - m) / torch.sqrt(v + eps)
def _scatter_add(tgt, idx, src, axis=0):
    return tgt.clone().index_add_(axis, idx, src)
def _segment_sum(src, seg, n):
    out = torch.zeros((n,) + src.shape[1:], dtype=src.dtype)
    return out.index_add_(0, seg, src)
def _pad(x, pw):
    flat = tuple(v for pair in reversed(pw) for v in pair)
    return torch.nn.functional.pad(x, flat)

kernel_name = 'concat_heads__gqa_block_cached__gqa_block_cached__near_ridge'

def setup_inputs():

    _w = (lambda a: (lambda t: t.to(torch.bfloat16) if t.is_floating_point() else t)(torch.as_tensor(a)))
    def _A_setup():
        B, Sq, D = 16, 64, 448
        Hq, Hkv, Sk, Dh = 16, 8, 1024, 256
        assert Hq % Hkv == 0, (Hq, Hkv)
        return {
            "x": _w((lambda *s: torch.randn(*s, dtype=torch.bfloat16) * 0.8)(B, Sq, D)),
            "k_cache": _w((lambda *s: torch.randn(*s, dtype=torch.bfloat16) * 0.8)(B, Hkv, Sk, Dh)),
            "v_cache": _w((lambda *s: torch.randn(*s, dtype=torch.bfloat16) * 0.05)(B, Hkv, Sk, Dh)),
            "wq": _w((lambda *s: torch.randn(*s, dtype=torch.bfloat16) * 0.8)(D, Hq * Dh) * (D ** -0.5)),
            "wo": _w((lambda *s: torch.randn(*s, dtype=torch.bfloat16) * 0.05)(Hq * Dh, D) * ((Hq * Dh) ** -0.5)),
        }
    _A_in = _A_setup()

    def _B_setup():
        B, Sq, D = 16, 64, 448
        Hq, Hkv, Sk, Dh = 16, 8, 1024, 256
        assert Hq % Hkv == 0, (Hq, Hkv)
        return {
            "x": _w((lambda *s: torch.randn(*s, dtype=torch.bfloat16) * 0.8)(B, Sq, D)),
            "k_cache": _w((lambda *s: torch.randn(*s, dtype=torch.bfloat16) * 0.8)(B, Hkv, Sk, Dh)),
            "v_cache": _w((lambda *s: torch.randn(*s, dtype=torch.bfloat16) * 0.05)(B, Hkv, Sk, Dh)),
            "wq": _w((lambda *s: torch.randn(*s, dtype=torch.bfloat16) * 0.8)(D, Hq * Dh) * (D ** -0.5)),
            "wo": _w((lambda *s: torch.randn(*s, dtype=torch.bfloat16) * 0.05)(Hq * Dh, D) * ((Hq * Dh) ** -0.5)),
        }
    _B_in = _B_setup()

    return {
        "A_x": _A_in["x"],
        "A_k_cache": _A_in["k_cache"],
        "A_v_cache": _A_in["v_cache"],
        "A_wq": _A_in["wq"],
        "A_wo": _A_in["wo"],
        "B_x": _B_in["x"],
        "B_k_cache": _B_in["k_cache"],
        "B_v_cache": _B_in["v_cache"],
        "B_wq": _B_in["wq"],
        "B_wo": _B_in["wo"],
    }

def reference(A_x, A_k_cache, A_v_cache, A_wq, A_wo, B_x, B_k_cache, B_v_cache, B_wq, B_wo):
    def _A_ref(x, k_cache, v_cache, wq, wo):
        B, Sq, D = x.shape
        Hq, Dh = 16, 256
        Hkv = k_cache.shape[1]
        rep = Hq // Hkv
        q = (lambda x, *d: x.permute(*d))((x @ wq).reshape(B, Sq, Hq, Dh), 0, 2, 1, 3)
        k = (lambda x, n, axis: torch.repeat_interleave(x, n, dim=axis))(k_cache, rep, axis=1)
        v = (lambda x, n, axis: torch.repeat_interleave(x, n, dim=axis))(v_cache, rep, axis=1)
        scores = torch.einsum("bhqd,bhkd->bhqk", q, k) * (Dh ** -0.5)
        p = _softmax(scores, axis=-1)
        o = torch.einsum("bhqk,bhkd->bhqd", p, v)
        return (lambda x, *d: x.permute(*d))(o, 0, 2, 1, 3).reshape(B, Sq, Hq * Dh) @ wo

    def _B_ref(x, k_cache, v_cache, wq, wo):
        B, Sq, D = x.shape
        Hq, Dh = 16, 256
        Hkv = k_cache.shape[1]
        rep = Hq // Hkv
        q = (lambda x, *d: x.permute(*d))((x @ wq).reshape(B, Sq, Hq, Dh), 0, 2, 1, 3)
        k = (lambda x, n, axis: torch.repeat_interleave(x, n, dim=axis))(k_cache, rep, axis=1)
        v = (lambda x, n, axis: torch.repeat_interleave(x, n, dim=axis))(v_cache, rep, axis=1)
        scores = torch.einsum("bhqd,bhkd->bhqk", q, k) * (Dh ** -0.5)
        p = _softmax(scores, axis=-1)
        o = torch.einsum("bhqk,bhkd->bhqd", p, v)
        return (lambda x, *d: x.permute(*d))(o, 0, 2, 1, 3).reshape(B, Sq, Hq * Dh) @ wo

    a = _A_ref(A_x, A_k_cache, A_v_cache, A_wq, A_wo)
    b = _B_ref(B_x, B_k_cache, B_v_cache, B_wq, B_wo)
    return torch.concatenate([a, b], axis=-1)
```

```asm
; @launch kernel=attn_kernel grid=(256,1,1) block=(256,1,1) lds=163840
; @launch kernel=reduce_kernel grid=(448,1,1) block=(256,1,1) lds=0
.amdgcn_target "amdgcn-amd-amdhsa--gfx950"
.text
.globl attn_kernel
.globl reduce_kernel
.type attn_kernel,@function
.type reduce_kernel,@function
.p2align 8
attn_kernel:
    s_cmp_ge_u32 s2, 256
    s_cbranch_scc1 L_attn_end
    s_load_dwordx16 s[36:51], s[0:1], 0
    s_load_dwordx4 s[52:55], s[0:1], 64
    s_load_dwordx2 s[56:57], s[0:1], 96
    v_lshrrev_b32 v1, 6, v0
    v_and_b32 v0, 63, v0
    v_readfirstlane_b32 s3, v1
    s_bfe_u32 s7, s2, 0x10002
    s_bfe_u32 s4, s2, 0x10001
    s_lshl_b32 s4, s4, 2
    s_bfe_u32 s5, s2, 0x20003
    s_add_u32 s4, s4, s5
    s_and_b32 s6, s2, 1
    s_lshl_b32 s6, s6, 3
    s_lshr_b32 s75, s2, 5
    s_add_u32 s6, s6, s75
    s_lshl_b32 s5, s7, 4
    s_add_u32 s5, s5, s6
    s_lshl_b32 s5, s5, 3
    s_add_u32 s5, s5, s4
    s_and_b32 s65, s3, 1
    s_lshr_b32 s66, s3, 1
    s_lshl_b32 s32, s3, 13
    v_xor_b32 v8, 0, v0
    v_lshlrev_b32 v8, 4, v8
    v_xor_b32 v9, 4, v0
    v_lshlrev_b32 v9, 4, v9
    v_add_u32 v9, 0x1c00, v9
    v_xor_b32 v10, 8, v0
    v_lshlrev_b32 v10, 4, v10
    v_add_u32 v10, 0x3800, v10
    v_xor_b32 v11, 12, v0
    v_lshlrev_b32 v11, 4, v11
    v_add_u32 v11, 0x5400, v11
    v_xor_b32 v68, 0, v0
    v_lshlrev_b32 v68, 4, v68
    v_add_u32 v68, 0x8000, v68
    v_xor_b32 v69, 4, v0
    v_lshlrev_b32 v69, 4, v69
    v_add_u32 v69, 0x9c00, v69
    v_xor_b32 v70, 8, v0
    v_lshlrev_b32 v70, 4, v70
    v_add_u32 v70, 0xb800, v70
    v_xor_b32 v71, 12, v0
    v_lshlrev_b32 v71, 4, v71
    v_add_u32 v71, 0xd400, v71
    s_mul_i32 s80, s75, 7
    s_lshr_b32 s80, s80, 2
    s_lshl_b32 s58, s3, 16
    s_lshl_b32 s60, s4, 10
    s_add_u32 s58, s58, s60
    s_add_u32 s73, s58, 0x380000
    s_lshl_b32 s60, s80, 18
    s_add_u32 s58, s58, s60
    s_lshl_b32 s81, s80, 2
    v_xor_b32 v96, 0, v0
    v_add_u32 v96, s81, v96
    v_subrev_u32 v7, 56, v96
    v_min_u32 v96, v7, v96
    v_lshlrev_b32 v96, 4, v96
    v_xor_b32 v97, 1, v0
    v_add_u32 v97, s81, v97
    v_subrev_u32 v7, 56, v97
    v_min_u32 v97, v7, v97
    v_lshlrev_b32 v97, 4, v97
    v_xor_b32 v98, 2, v0
    v_add_u32 v98, s81, v98
    v_subrev_u32 v7, 56, v98
    v_min_u32 v98, v7, v98
    v_lshlrev_b32 v98, 4, v98
    v_xor_b32 v99, 3, v0
    v_add_u32 v99, s81, v99
    v_subrev_u32 v7, 56, v99
    v_min_u32 v99, v7, v99
    v_lshlrev_b32 v99, 4, v99
    v_xor_b32 v100, 4, v0
    v_add_u32 v100, s81, v100
    v_subrev_u32 v7, 56, v100
    v_min_u32 v100, v7, v100
    v_lshlrev_b32 v100, 4, v100
    v_xor_b32 v101, 5, v0
    v_add_u32 v101, s81, v101
    v_subrev_u32 v7, 56, v101
    v_min_u32 v101, v7, v101
    v_lshlrev_b32 v101, 4, v101
    v_xor_b32 v102, 6, v0
    v_add_u32 v102, s81, v102
    v_subrev_u32 v7, 56, v102
    v_min_u32 v102, v7, v102
    v_lshlrev_b32 v102, 4, v102
    v_xor_b32 v103, 7, v0
    v_add_u32 v103, s81, v103
    v_subrev_u32 v7, 56, v103
    v_min_u32 v103, v7, v103
    v_lshlrev_b32 v103, 4, v103
    v_xor_b32 v104, 8, v0
    v_add_u32 v104, s81, v104
    v_subrev_u32 v7, 56, v104
    v_min_u32 v104, v7, v104
    v_lshlrev_b32 v104, 4, v104
    v_xor_b32 v105, 9, v0
    v_add_u32 v105, s81, v105
    v_subrev_u32 v7, 56, v105
    v_min_u32 v105, v7, v105
    v_lshlrev_b32 v105, 4, v105
    v_xor_b32 v106, 10, v0
    v_add_u32 v106, s81, v106
    v_subrev_u32 v7, 56, v106
    v_min_u32 v106, v7, v106
    v_lshlrev_b32 v106, 4, v106
    v_xor_b32 v107, 11, v0
    v_add_u32 v107, s81, v107
    v_subrev_u32 v7, 56, v107
    v_min_u32 v107, v7, v107
    v_lshlrev_b32 v107, 4, v107
    v_xor_b32 v108, 12, v0
    v_add_u32 v108, s81, v108
    v_subrev_u32 v7, 56, v108
    v_min_u32 v108, v7, v108
    v_lshlrev_b32 v108, 4, v108
    v_xor_b32 v109, 13, v0
    v_add_u32 v109, s81, v109
    v_subrev_u32 v7, 56, v109
    v_min_u32 v109, v7, v109
    v_lshlrev_b32 v109, 4, v109
    v_xor_b32 v110, 14, v0
    v_add_u32 v110, s81, v110
    v_subrev_u32 v7, 56, v110
    v_min_u32 v110, v7, v110
    v_lshlrev_b32 v110, 4, v110
    v_xor_b32 v111, 15, v0
    v_add_u32 v111, s81, v111
    v_subrev_u32 v7, 56, v111
    v_min_u32 v111, v7, v111
    v_lshlrev_b32 v111, 4, v111
    s_lshl_b32 s61, s6, 6
    s_lshl_b32 s63, s3, 4
    s_add_u32 s61, s61, s63
    s_mul_i32 s61, s61, 896
    s_and_b32 s63, s3, 1
    s_lshl_b32 s63, s63, 14
    s_mov_b32 s82, 0x0
    s_cmp_eq_u32 s66, 0
    s_cselect_b32 s82, 0x20000, s82
    s_add_u32 s63, s63, s82
    s_waitcnt lgkmcnt(0)
    s_cmp_eq_u32 s7, 0
    s_cselect_b32 s8, s36, s46
    s_cselect_b32 s9, s37, s47
    s_mov_b32 s10, 0xe0000
    s_mov_b32 s11, 0x20000
    s_cselect_b32 s20, s42, s52
    s_cselect_b32 s21, s43, s53
    s_mov_b32 s22, 0x380000
    s_mov_b32 s23, 0x20000
    s_cselect_b32 s12, s38, s48
    s_cselect_b32 s13, s39, s49
    s_mov_b32 s14, 0x4000000
    s_mov_b32 s15, 0x20000
    s_cselect_b32 s16, s40, s50
    s_cselect_b32 s17, s41, s51
    s_mov_b32 s18, 0x4000000
    s_mov_b32 s19, 0x20000
    s_cselect_b32 s24, s44, s54
    s_cselect_b32 s25, s45, s55
    s_mov_b32 s26, 0x380000
    s_mov_b32 s27, 0x20000
    s_add_u32 m0, s63, 0x0
    s_add_u32 s60, s61, 0
    buffer_load_dwordx4 v96, s[8:11], s60 offen lds
    s_add_u32 m0, s63, 0x400
    s_add_u32 s60, s61, 896
    buffer_load_dwordx4 v97, s[8:11], s60 offen lds
    s_add_u32 m0, s63, 0x800
    s_add_u32 s60, s61, 1792
    buffer_load_dwordx4 v98, s[8:11], s60 offen lds
    s_add_u32 m0, s63, 0xc00
    s_add_u32 s60, s61, 2688
    buffer_load_dwordx4 v99, s[8:11], s60 offen lds
    s_add_u32 m0, s63, 0x1000
    s_add_u32 s60, s61, 3584
    buffer_load_dwordx4 v100, s[8:11], s60 offen lds
    s_add_u32 m0, s63, 0x1400
    s_add_u32 s60, s61, 4480
    buffer_load_dwordx4 v101, s[8:11], s60 offen lds
    s_add_u32 m0, s63, 0x1800
    s_add_u32 s60, s61, 5376
    buffer_load_dwordx4 v102, s[8:11], s60 offen lds
    s_add_u32 m0, s63, 0x1c00
    s_add_u32 s60, s61, 6272
    buffer_load_dwordx4 v103, s[8:11], s60 offen lds
    s_add_u32 m0, s63, 0x2000
    s_add_u32 s60, s61, 7168
    buffer_load_dwordx4 v104, s[8:11], s60 offen lds
    s_add_u32 m0, s63, 0x2400
    s_add_u32 s60, s61, 8064
    buffer_load_dwordx4 v105, s[8:11], s60 offen lds
    s_add_u32 m0, s63, 0x2800
    s_add_u32 s60, s61, 8960
    buffer_load_dwordx4 v106, s[8:11], s60 offen lds
    s_add_u32 m0, s63, 0x2c00
    s_add_u32 s60, s61, 9856
    buffer_load_dwordx4 v107, s[8:11], s60 offen lds
    s_add_u32 m0, s63, 0x3000
    s_add_u32 s60, s61, 10752
    buffer_load_dwordx4 v108, s[8:11], s60 offen lds
    s_add_u32 m0, s63, 0x3400
    s_add_u32 s60, s61, 11648
    buffer_load_dwordx4 v109, s[8:11], s60 offen lds
    s_add_u32 m0, s63, 0x3800
    s_add_u32 s60, s61, 12544
    buffer_load_dwordx4 v110, s[8:11], s60 offen lds
    s_add_u32 m0, s63, 0x3c00
    s_add_u32 s60, s61, 13440
    buffer_load_dwordx4 v111, s[8:11], s60 offen lds
    s_add_u32 m0, s32, 0x8000
    s_nop 0
    buffer_load_dwordx4 v8, s[20:23], s58 offen offset:0 lds
    buffer_load_dwordx4 v9, s[20:23], s58 offen offset:1024 lds
    buffer_load_dwordx4 v10, s[20:23], s58 offen offset:2048 lds
    buffer_load_dwordx4 v11, s[20:23], s58 offen offset:3072 lds
    s_add_u32 m0, s32, 0x9000
    s_nop 0
    buffer_load_dwordx4 v68, s[20:23], s58 offen offset:0 lds
    buffer_load_dwordx4 v69, s[20:23], s58 offen offset:1024 lds
    buffer_load_dwordx4 v70, s[20:23], s58 offen offset:2048 lds
    buffer_load_dwordx4 v71, s[20:23], s58 offen offset:3072 lds
    s_add_u32 s58, s58, 0x40000
    s_cmp_ge_u32 s58, s73
    s_cselect_b32 s60, 0x380000, 0
    s_sub_u32 s58, s58, s60
    s_add_u32 m0, s32, 0x10000
    s_nop 0
    buffer_load_dwordx4 v8, s[20:23], s58 offen offset:0 lds
    buffer_load_dwordx4 v9, s[20:23], s58 offen offset:1024 lds
    buffer_load_dwordx4 v10, s[20:23], s58 offen offset:2048 lds
    buffer_load_dwordx4 v11, s[20:23], s58 offen offset:3072 lds
    s_add_u32 m0, s32, 0x11000
    s_nop 0
    buffer_load_dwordx4 v68, s[20:23], s58 offen offset:0 lds
    buffer_load_dwordx4 v69, s[20:23], s58 offen offset:1024 lds
    buffer_load_dwordx4 v70, s[20:23], s58 offen offset:2048 lds
    buffer_load_dwordx4 v71, s[20:23], s58 offen offset:3072 lds
    s_add_u32 s58, s58, 0x40000
    s_cmp_ge_u32 s58, s73
    s_cselect_b32 s60, 0x380000, 0
    s_sub_u32 s58, s58, s60
    s_add_u32 m0, s32, 0x18000
    s_nop 0
    buffer_load_dwordx4 v8, s[20:23], s58 offen offset:0 lds
    buffer_load_dwordx4 v9, s[20:23], s58 offen offset:1024 lds
    buffer_load_dwordx4 v10, s[20:23], s58 offen offset:2048 lds
    buffer_load_dwordx4 v11, s[20:23], s58 offen offset:3072 lds
    s_add_u32 m0, s32, 0x19000
    s_nop 0
    buffer_load_dwordx4 v68, s[20:23], s58 offen offset:0 lds
    buffer_load_dwordx4 v69, s[20:23], s58 offen offset:1024 lds
    buffer_load_dwordx4 v70, s[20:23], s58 offen offset:2048 lds
    buffer_load_dwordx4 v71, s[20:23], s58 offen offset:3072 lds
    s_add_u32 s58, s58, 0x40000
    s_cmp_ge_u32 s58, s73
    s_cselect_b32 s60, 0x380000, 0
    s_sub_u32 s58, s58, s60
    s_sub_u32 s24, s24, 0x1000
    s_subb_u32 s25, s25, 0
    s_mov_b32 s26, 0x381000
    s_mov_b32 s28, s56
    s_mov_b32 s29, s57
    s_mov_b32 s30, 0x1c00000
    s_mov_b32 s31, 0x20000
    s_lshl_b32 s60, s6, 3
    s_add_u32 s60, s60, s4
    s_lshl_b32 s60, s60, 19
    s_add_u32 s33, s60, s32
    s_lshl_b32 s60, s4, 6
    s_add_u32 s60, s60, s3
    s_mul_i32 s59, s60, 7168
    s_add_u32 s74, s59, 0x70000
    s_mul_i32 s60, s75, 57344
    s_add_u32 s59, s59, s60
    s_mov_b32 s35, 0x3db8aa3b
    v_lshrrev_b32 v1, 5, v0
    v_and_b32 v2, 31, v0
    v_and_b32 v3, 15, v0
    v_bfe_u32 v4, v0, 4, 1
    v_bfe_u32 v5, v0, 2, 2
    v_and_b32 v6, 3, v0
    v_xor_b32 v7, v2, v1
    v_xor_b32 v12, 0, v7
    v_lshlrev_b32 v12, 4, v12
    v_lshl_add_u32 v12, v1, 9, v12
    v_xor_b32 v13, 2, v7
    v_lshlrev_b32 v13, 4, v13
    v_lshl_add_u32 v13, v1, 9, v13
    v_xor_b32 v14, 4, v7
    v_lshlrev_b32 v14, 4, v14
    v_lshl_add_u32 v14, v1, 9, v14
    v_xor_b32 v15, 6, v7
    v_lshlrev_b32 v15, 4, v15
    v_lshl_add_u32 v15, v1, 9, v15
    v_xor_b32 v16, 8, v7
    v_lshlrev_b32 v16, 4, v16
    v_lshl_add_u32 v16, v1, 9, v16
    v_xor_b32 v17, 10, v7
    v_lshlrev_b32 v17, 4, v17
    v_lshl_add_u32 v17, v1, 9, v17
    v_xor_b32 v18, 12, v7
    v_lshlrev_b32 v18, 4, v18
    v_lshl_add_u32 v18, v1, 9, v18
    v_xor_b32 v19, 14, v7
    v_lshlrev_b32 v19, 4, v19
    v_lshl_add_u32 v19, v1, 9, v19
    v_lshlrev_b32 v7, 2, v1
    v_xor_b32 v7, v7, v2
    v_xor_b32 v20, 0, v7
    v_lshlrev_b32 v20, 4, v20
    v_lshl_add_u32 v20, v1, 9, v20
    v_xor_b32 v21, 8, v7
    v_lshlrev_b32 v21, 4, v21
    v_lshl_add_u32 v21, v1, 9, v21
    v_xor_b32 v7, v1, v3
    v_lshlrev_b32 v7, 4, v7
    v_xor_b32 v22, 0, v7
    v_lshl_add_u32 v22, v2, 9, v22
    v_xor_b32 v23, 32, v7
    v_lshl_add_u32 v23, v2, 9, v23
    v_xor_b32 v24, 64, v7
    v_lshl_add_u32 v24, v2, 9, v24
    v_xor_b32 v25, 96, v7
    v_lshl_add_u32 v25, v2, 9, v25
    v_xor_b32 v26, 128, v7
    v_lshl_add_u32 v26, v2, 9, v26
    v_xor_b32 v27, 160, v7
    v_lshl_add_u32 v27, v2, 9, v27
    v_xor_b32 v28, 192, v7
    v_lshl_add_u32 v28, v2, 9, v28
    v_xor_b32 v29, 224, v7
    v_lshl_add_u32 v29, v2, 9, v29
    s_mov_b32 s82, 0x0
    s_cmp_eq_u32 s65, 0
    s_cselect_b32 s60, 0x20000, s82
    v_xor_b32 v38, 0, v7
    v_lshl_add_u32 v38, v2, 10, v38
    v_add_u32 v38, s60, v38
    v_xor_b32 v39, 32, v7
    v_lshl_add_u32 v39, v2, 10, v39
    v_add_u32 v39, s60, v39
    v_xor_b32 v40, 64, v7
    v_lshl_add_u32 v40, v2, 10, v40
    v_add_u32 v40, s60, v40
    v_xor_b32 v41, 96, v7
    v_lshl_add_u32 v41, v2, 10, v41
    v_add_u32 v41, s60, v41
    v_xor_b32 v42, 128, v7
    v_lshl_add_u32 v42, v2, 10, v42
    v_add_u32 v42, s60, v42
    v_xor_b32 v43, 160, v7
    v_lshl_add_u32 v43, v2, 10, v43
    v_add_u32 v43, s60, v43
    v_xor_b32 v44, 192, v7
    v_lshl_add_u32 v44, v2, 10, v44
    v_add_u32 v44, s60, v44
    v_xor_b32 v45, 224, v7
    v_lshl_add_u32 v45, v2, 10, v45
    v_add_u32 v45, s60, v45
    v_lshl_add_u32 v7, v1, 2, v5
    v_lshlrev_b32 v7, 9, v7
    v_lshl_add_u32 v7, v4, 5, v7
    v_lshl_add_u32 v7, v6, 3, v7
    v_xor_b32 v30, 0, v5
    v_lshl_add_u32 v30, v30, 6, v7
    v_xor_b32 v31, 1, v5
    v_lshl_add_u32 v31, v31, 6, v7
    v_xor_b32 v32, 2, v5
    v_lshl_add_u32 v32, v32, 6, v7
    v_xor_b32 v33, 3, v5
    v_lshl_add_u32 v33, v33, 6, v7
    v_lshl_add_u32 v7, v1, 3, v5
    v_lshlrev_b32 v7, 10, v7
    v_lshl_add_u32 v7, v4, 5, v7
    s_lshl_b32 s60, s66, 9
    v_add_u32 v7, s60, v7
    v_and_b32 v62, 1, v6
    v_lshrrev_b32 v63, 1, v6
    v_lshl_add_u32 v62, v62, 1, v63
    v_lshl_add_u32 v7, v62, 3, v7
    v_xor_b32 v34, 0, v5
    v_lshl_add_u32 v34, v34, 6, v7
    v_xor_b32 v35, 1, v5
    v_lshl_add_u32 v35, v35, 6, v7
    v_xor_b32 v36, 2, v5
    v_lshl_add_u32 v36, v36, 6, v7
    v_xor_b32 v37, 3, v5
    v_lshl_add_u32 v37, v37, 6, v7
    v_lshl_add_u32 v7, v1, 2, v5
    v_lshlrev_b32 v7, 10, v7
    v_lshl_add_u32 v7, v4, 5, v7
    v_lshl_add_u32 v7, v6, 3, v7
    s_mul_i32 s61, s66, 7
    s_add_u32 s60, s61, 0
    s_and_b32 s67, s60, 3
    s_lshr_b32 s60, s60, 2
    s_lshl_b32 s60, s60, 8
    v_xor_b32 v46, s67, v5
    v_lshl_add_u32 v46, v46, 6, v7
    v_add_u32 v46, s60, v46
    s_add_u32 s60, s61, 1
    s_and_b32 s67, s60, 3
    s_lshr_b32 s60, s60, 2
    s_lshl_b32 s60, s60, 8
    v_xor_b32 v47, s67, v5
    v_lshl_add_u32 v47, v47, 6, v7
    v_add_u32 v47, s60, v47
    s_add_u32 s60, s61, 2
    s_and_b32 s67, s60, 3
    s_lshr_b32 s60, s60, 2
    s_lshl_b32 s60, s60, 8
    v_xor_b32 v48, s67, v5
    v_lshl_add_u32 v48, v48, 6, v7
    v_add_u32 v48, s60, v48
    s_add_u32 s60, s61, 3
    s_and_b32 s67, s60, 3
    s_lshr_b32 s60, s60, 2
    s_lshl_b32 s60, s60, 8
    v_xor_b32 v49, s67, v5
    v_lshl_add_u32 v49, v49, 6, v7
    v_add_u32 v49, s60, v49
    s_add_u32 s60, s61, 4
    s_and_b32 s67, s60, 3
    s_lshr_b32 s60, s60, 2
    s_lshl_b32 s60, s60, 8
    v_xor_b32 v50, s67, v5
    v_lshl_add_u32 v50, v50, 6, v7
    v_add_u32 v50, s60, v50
    s_add_u32 s60, s61, 5
    s_and_b32 s67, s60, 3
    s_lshr_b32 s60, s60, 2
    s_lshl_b32 s60, s60, 8
    v_xor_b32 v51, s67, v5
    v_lshl_add_u32 v51, v51, 6, v7
    v_add_u32 v51, s60, v51
    s_add_u32 s60, s61, 6
    s_and_b32 s67, s60, 3
    s_lshr_b32 s60, s60, 2
    s_lshl_b32 s60, s60, 8
    v_xor_b32 v52, s67, v5
    v_lshl_add_u32 v52, v52, 6, v7
    v_add_u32 v52, s60, v52
    s_waitcnt vmcnt(16)
    s_barrier
    ds_read_b128 a[128:131], v38 offset:0
    ds_read_b128 a[132:135], v39 offset:0
    ds_read_b128 a[136:139], v40 offset:0
    ds_read_b128 a[140:143], v41 offset:0
    ds_read_b128 a[144:147], v42 offset:0
    ds_read_b128 a[148:151], v43 offset:0
    ds_read_b128 a[152:155], v44 offset:0
    ds_read_b128 a[156:159], v45 offset:0
    ds_read_b128 a[160:163], v38 offset:256
    ds_read_b128 a[164:167], v39 offset:256
    ds_read_b128 a[168:171], v40 offset:256
    ds_read_b128 a[172:175], v41 offset:256
    ds_read_b128 a[176:179], v42 offset:256
    ds_read_b128 a[180:183], v43 offset:256
    s_waitcnt lgkmcnt(0)
    ds_read_b128 a[184:187], v44 offset:256
    ds_read_b128 a[188:191], v45 offset:256
    ds_read_b128 a[192:195], v38 offset:512
    ds_read_b128 a[196:199], v39 offset:512
    ds_read_b128 a[200:203], v40 offset:512
    ds_read_b128 a[204:207], v41 offset:512
    ds_read_b128 a[208:211], v42 offset:512
    ds_read_b128 a[212:215], v43 offset:512
    ds_read_b128 a[216:219], v44 offset:512
    ds_read_b128 a[220:223], v45 offset:512
    ds_read_b128 a[224:227], v38 offset:768
    ds_read_b128 a[228:231], v39 offset:768
    ds_read_b128 a[232:235], v40 offset:768
    ds_read_b128 a[236:239], v41 offset:768
    s_waitcnt lgkmcnt(0)
    s_barrier
    v_add_u32 v38, 0x8000, v34
    v_add_u32 v39, 0x8000, v35
    v_add_u32 v40, 0x8000, v36
    v_add_u32 v41, 0x8000, v37
    ds_read_b64_tr_b16 a[64:65], v38 offset:0
    ds_read_b64_tr_b16 a[66:67], v38 offset:4096
    ds_read_b64_tr_b16 a[68:69], v39 offset:0
    ds_read_b64_tr_b16 a[70:71], v39 offset:4096
    ds_read_b64_tr_b16 a[72:73], v40 offset:0
    ds_read_b64_tr_b16 a[74:75], v40 offset:4096
    ds_read_b64_tr_b16 a[76:77], v41 offset:0
    ds_read_b64_tr_b16 a[78:79], v41 offset:4096
    ds_read_b64_tr_b16 a[80:81], v38 offset:256
    ds_read_b64_tr_b16 a[82:83], v38 offset:4352
    ds_read_b64_tr_b16 a[84:85], v39 offset:256
    ds_read_b64_tr_b16 a[86:87], v39 offset:4352
    s_waitcnt lgkmcnt(10)
    v_mfma_f32_32x32x16_bf16 v[128:143], a[64:67], a[128:131], 0
    ds_read_b64_tr_b16 a[88:89], v40 offset:256
    ds_read_b64_tr_b16 a[90:91], v40 offset:4352
    s_add_u32 m0, s32, 0x20000
    s_nop 0
    buffer_load_dwordx4 v8, s[20:23], s58 offen offset:0 lds
    s_waitcnt lgkmcnt(10)
    v_mfma_f32_32x32x16_bf16 v[144:159], a[68:71], a[128:131], 0
    ds_read_b64_tr_b16 a[92:93], v41 offset:256
    ds_read_b64_tr_b16 a[94:95], v41 offset:4352
    buffer_load_dwordx4 v9, s[20:23], s58 offen offset:1024 lds
    s_waitcnt lgkmcnt(10)
    v_mfma_f32_32x32x16_bf16 v[160:175], a[72:75], a[128:131], 0
    ds_read_b64_tr_b16 a[96:97], v38 offset:16384
    ds_read_b64_tr_b16 a[98:99], v38 offset:20480
    buffer_load_dwordx4 v10, s[20:23], s58 offen offset:2048 lds
    s_waitcnt lgkmcnt(10)
    v_mfma_f32_32x32x16_bf16 v[176:191], a[76:79], a[128:131], 0
    ds_read_b64_tr_b16 a[100:101], v39 offset:16384
    ds_read_b64_tr_b16 a[102:103], v39 offset:20480
    buffer_load_dwordx4 v11, s[20:23], s58 offen offset:3072 lds
    s_waitcnt lgkmcnt(10)
    v_mfma_f32_32x32x16_bf16 v[192:207], a[80:83], a[128:131], 0
    ds_read_b64_tr_b16 a[104:105], v40 offset:16384
    ds_read_b64_tr_b16 a[106:107], v40 offset:20480
    s_add_u32 m0, s32, 0x21000
    s_nop 0
    buffer_load_dwordx4 v68, s[20:23], s58 offen offset:0 lds
    s_waitcnt lgkmcnt(10)
    v_mfma_f32_32x32x16_bf16 v[208:223], a[84:87], a[128:131], 0
    ds_read_b64_tr_b16 a[108:109], v41 offset:16384
    ds_read_b64_tr_b16 a[110:111], v41 offset:20480
    buffer_load_dwordx4 v69, s[20:23], s58 offen offset:1024 lds
    s_waitcnt lgkmcnt(10)
    v_mfma_f32_32x32x16_bf16 v[224:239], a[88:91], a[128:131], 0
    ds_read_b64_tr_b16 a[112:113], v38 offset:16640
    ds_read_b64_tr_b16 a[114:115], v38 offset:20736
    buffer_load_dwordx4 v70, s[20:23], s58 offen offset:2048 lds
    s_waitcnt lgkmcnt(10)
    v_mfma_f32_32x32x16_bf16 v[240:255], a[92:95], a[128:131], 0
    ds_read_b64_tr_b16 a[116:117], v39 offset:16640
    ds_read_b64_tr_b16 a[118:119], v39 offset:20736
    buffer_load_dwordx4 v71, s[20:23], s58 offen offset:3072 lds
    s_add_u32 s58, s58, 0x40000
    s_cmp_ge_u32 s58, s73
    s_cselect_b32 s60, 0x380000, 0
    s_sub_u32 s58, s58, s60
    s_waitcnt lgkmcnt(10)
    v_mfma_f32_32x32x16_bf16 v[128:143], a[96:99], a[132:135], v[128:143]
    ds_read_b64_tr_b16 a[120:121], v40 offset:16640
    ds_read_b64_tr_b16 a[122:123], v40 offset:20736
    s_add_u32 m0, s32, 0x0
    s_nop 0
    buffer_load_dwordx4 v8, s[20:23], s58 offen offset:0 lds
    s_waitcnt lgkmcnt(10)
    v_mfma_f32_32x32x16_bf16 v[144:159], a[100:103], a[132:135], v[144:159]
    ds_read_b64_tr_b16 a[124:125], v41 offset:16640
    ds_read_b64_tr_b16 a[126:127], v41 offset:20736
    buffer_load_dwordx4 v9, s[20:23], s58 offen offset:1024 lds
    s_waitcnt lgkmcnt(10)
    v_mfma_f32_32x32x16_bf16 v[160:175], a[104:107], a[132:135], v[160:175]
    buffer_load_dwordx4 v10, s[20:23], s58 offen offset:2048 lds
    s_waitcnt lgkmcnt(8)
    v_mfma_f32_32x32x16_bf16 v[176:191], a[108:111], a[132:135], v[176:191]
    buffer_load_dwordx4 v11, s[20:23], s58 offen offset:3072 lds
    s_waitcnt lgkmcnt(6)
    v_mfma_f32_32x32x16_bf16 v[192:207], a[112:115], a[132:135], v[192:207]
    s_add_u32 m0, s32, 0x1000
    s_nop 0
    buffer_load_dwordx4 v68, s[20:23], s58 offen offset:0 lds
    s_waitcnt lgkmcnt(4)
    v_mfma_f32_32x32x16_bf16 v[208:223], a[116:119], a[132:135], v[208:223]
    buffer_load_dwordx4 v69, s[20:23], s58 offen offset:1024 lds
    buffer_load_dwordx4 v70, s[20:23], s58 offen offset:2048 lds
    buffer_load_dwordx4 v71, s[20:23], s58 offen offset:3072 lds
    s_add_u32 s58, s58, 0x40000
    s_cmp_ge_u32 s58, s73
    s_cselect_b32 s60, 0x380000, 0
    s_sub_u32 s58, s58, s60
    s_waitcnt lgkmcnt(0)
    s_waitcnt vmcnt(24)
    s_barrier
    v_add_u32 v42, 0x10000, v34
    v_add_u32 v43, 0x10000, v35
    v_add_u32 v44, 0x10000, v36
    v_add_u32 v45, 0x10000, v37
    ds_read_b64_tr_b16 a[64:65], v42 offset:0
    ds_read_b64_tr_b16 a[66:67], v42 offset:4096
    ds_read_b64_tr_b16 a[68:69], v43 offset:0
    ds_read_b64_tr_b16 a[70:71], v43 offset:4096
    ds_read_b64_tr_b16 a[72:73], v44 offset:0
    ds_read_b64_tr_b16 a[74:75], v44 offset:4096
    ds_read_b64_tr_b16 a[76:77], v45 offset:0
    ds_read_b64_tr_b16 a[78:79], v45 offset:4096
    s_add_u32 m0, s32, 0x8000
    s_nop 0
    buffer_load_dwordx4 v8, s[20:23], s58 offen offset:0 lds
    s_waitcnt lgkmcnt(10)
    v_mfma_f32_32x32x16_bf16 v[224:239], a[120:123], a[132:135], v[224:239]
    ds_read_b64_tr_b16 a[80:81], v42 offset:256
    ds_read_b64_tr_b16 a[82:83], v42 offset:4352
    buffer_load_dwordx4 v9, s[20:23], s58 offen offset:1024 lds
    s_waitcnt lgkmcnt(10)
    v_mfma_f32_32x32x16_bf16 v[240:255], a[124:127], a[132:135], v[240:255]
    ds_read_b64_tr_b16 a[84:85], v43 offset:256
    ds_read_b64_tr_b16 a[86:87], v43 offset:4352
    buffer_load_dwordx4 v10, s[20:23], s58 offen offset:2048 lds
    s_waitcnt lgkmcnt(10)
    v_mfma_f32_32x32x16_bf16 v[128:143], a[64:67], a[136:139], v[128:143]
    ds_read_b64_tr_b16 a[88:89], v44 offset:256
    ds_read_b64_tr_b16 a[90:91], v44 offset:4352
    buffer_load_dwordx4 v11, s[20:23], s58 offen offset:3072 lds
    s_waitcnt lgkmcnt(10)
    v_mfma_f32_32x32x16_bf16 v[144:159], a[68:71], a[136:139], v[144:159]
    ds_read_b64_tr_b16 a[92:93], v45 offset:256
    ds_read_b64_tr_b16 a[94:95], v45 offset:4352
    s_add_u32 m0, s32, 0x9000
    s_nop 0
    buffer_load_dwordx4 v68, s[20:23], s58 offen offset:0 lds
    s_waitcnt lgkmcnt(10)
    v_mfma_f32_32x32x16_bf16 v[160:175], a[72:75], a[136:139], v[160:175]
    ds_read_b64_tr_b16 a[96:97], v42 offset:16384
    ds_read_b64_tr_b16 a[98:99], v42 offset:20480
    buffer_load_dwordx4 v69, s[20:23], s58 offen offset:1024 lds
    s_waitcnt lgkmcnt(10)
    v_mfma_f32_32x32x16_bf16 v[176:191], a[76:79], a[136:139], v[176:191]
    ds_read_b64_tr_b16 a[100:101], v43 offset:16384
    ds_read_b64_tr_b16 a[102:103], v43 offset:20480
    buffer_load_dwordx4 v70, s[20:23], s58 offen offset:2048 lds
    s_waitcnt lgkmcnt(10)
    v_mfma_f32_32x32x16_bf16 v[192:207], a[80:83], a[136:139], v[192:207]
    ds_read_b64_tr_b16 a[104:105], v44 offset:16384
    ds_read_b64_tr_b16 a[106:107], v44 offset:20480
    buffer_load_dwordx4 v71, s[20:23], s58 offen offset:3072 lds
    s_add_u32 s58, s58, 0x40000
    s_cmp_ge_u32 s58, s73
    s_cselect_b32 s60, 0x380000, 0
    s_sub_u32 s58, s58, s60
    s_waitcnt lgkmcnt(10)
    v_mfma_f32_32x32x16_bf16 v[208:223], a[84:87], a[136:139], v[208:223]
    ds_read_b64_tr_b16 a[108:109], v45 offset:16384
    ds_read_b64_tr_b16 a[110:111], v45 offset:20480
    s_waitcnt lgkmcnt(10)
    v_mfma_f32_32x32x16_bf16 v[224:239], a[88:91], a[136:139], v[224:239]
    ds_read_b64_tr_b16 a[112:113], v42 offset:16640
    ds_read_b64_tr_b16 a[114:115], v42 offset:20736
    s_waitcnt lgkmcnt(10)
    v_mfma_f32_32x32x16_bf16 v[240:255], a[92:95], a[136:139], v[240:255]
    ds_read_b64_tr_b16 a[116:117], v43 offset:16640
    ds_read_b64_tr_b16 a[118:119], v43 offset:20736
    s_waitcnt lgkmcnt(10)
    v_mfma_f32_32x32x16_bf16 v[128:143], a[96:99], a[140:143], v[128:143]
    ds_read_b64_tr_b16 a[120:121], v44 offset:16640
    ds_read_b64_tr_b16 a[122:123], v44 offset:20736
    s_waitcnt lgkmcnt(10)
    v_mfma_f32_32x32x16_bf16 v[144:159], a[100:103], a[140:143], v[144:159]
    ds_read_b64_tr_b16 a[124:125], v45 offset:16640
    ds_read_b64_tr_b16 a[126:127], v45 offset:20736
    s_waitcnt lgkmcnt(10)
    v_mfma_f32_32x32x16_bf16 v[160:175], a[104:107], a[140:143], v[160:175]
    s_waitcnt lgkmcnt(8)
    v_mfma_f32_32x32x16_bf16 v[176:191], a[108:111], a[140:143], v[176:191]
    s_waitcnt lgkmcnt(6)
    v_mfma_f32_32x32x16_bf16 v[192:207], a[112:115], a[140:143], v[192:207]
    s_waitcnt lgkmcnt(4)
    v_mfma_f32_32x32x16_bf16 v[208:223], a[116:119], a[140:143], v[208:223]
    s_waitcnt lgkmcnt(0)
    s_waitcnt vmcnt(24)
    s_barrier
    v_add_u32 v38, 0x18000, v34
    v_add_u32 v39, 0x18000, v35
    v_add_u32 v40, 0x18000, v36
    v_add_u32 v41, 0x18000, v37
    ds_read_b64_tr_b16 a[64:65], v38 offset:0
    ds_read_b64_tr_b16 a[66:67], v38 offset:4096
    ds_read_b64_tr_b16 a[68:69], v39 offset:0
    ds_read_b64_tr_b16 a[70:71], v39 offset:4096
    ds_read_b64_tr_b16 a[72:73], v40 offset:0
    ds_read_b64_tr_b16 a[74:75], v40 offset:4096
    ds_read_b64_tr_b16 a[76:77], v41 offset:0
    ds_read_b64_tr_b16 a[78:79], v41 offset:4096
    s_add_u32 m0, s32, 0x10000
    s_nop 0
    buffer_load_dwordx4 v8, s[20:23], s58 offen offset:0 lds
    s_waitcnt lgkmcnt(10)
    v_mfma_f32_32x32x16_bf16 v[224:239], a[120:123], a[140:143], v[224:239]
    ds_read_b64_tr_b16 a[80:81], v38 offset:256
    ds_read_b64_tr_b16 a[82:83], v38 offset:4352
    buffer_load_dwordx4 v9, s[20:23], s58 offen offset:1024 lds
    s_waitcnt lgkmcnt(10)
    v_mfma_f32_32x32x16_bf16 v[240:255], a[124:127], a[140:143], v[240:255]
    ds_read_b64_tr_b16 a[84:85], v39 offset:256
    ds_read_b64_tr_b16 a[86:87], v39 offset:4352
    buffer_load_dwordx4 v10, s[20:23], s58 offen offset:2048 lds
    s_waitcnt lgkmcnt(10)
    v_mfma_f32_32x32x16_bf16 v[128:143], a[64:67], a[144:147], v[128:143]
    ds_read_b64_tr_b16 a[88:89], v40 offset:256
    ds_read_b64_tr_b16 a[90:91], v40 offset:4352
    buffer_load_dwordx4 v11, s[20:23], s58 offen offset:3072 lds
    s_waitcnt lgkmcnt(10)
    v_mfma_f32_32x32x16_bf16 v[144:159], a[68:71], a[144:147], v[144:159]
    ds_read_b64_tr_b16 a[92:93], v41 offset:256
    ds_read_b64_tr_b16 a[94:95], v41 offset:4352
    s_add_u32 m0, s32, 0x11000
    s_nop 0
    buffer_load_dwordx4 v68, s[20:23], s58 offen offset:0 lds
    s_waitcnt lgkmcnt(10)
    v_mfma_f32_32x32x16_bf16 v[160:175], a[72:75], a[144:147], v[160:175]
    ds_read_b64_tr_b16 a[96:97], v38 offset:16384
    ds_read_b64_tr_b16 a[98:99], v38 offset:20480
    buffer_load_dwordx4 v69, s[20:23], s58 offen offset:1024 lds
    s_waitcnt lgkmcnt(10)
    v_mfma_f32_32x32x16_bf16 v[176:191], a[76:79], a[144:147], v[176:191]
    ds_read_b64_tr_b16 a[100:101], v39 offset:16384
    ds_read_b64_tr_b16 a[102:103], v39 offset:20480
    buffer_load_dwordx4 v70, s[20:23], s58 offen offset:2048 lds
    s_waitcnt lgkmcnt(10)
    v_mfma_f32_32x32x16_bf16 v[192:207], a[80:83], a[144:147], v[192:207]
    ds_read_b64_tr_b16 a[104:105], v40 offset:16384
    ds_read_b64_tr_b16 a[106:107], v40 offset:20480
    buffer_load_dwordx4 v71, s[20:23], s58 offen offset:3072 lds
    s_add_u32 s58, s58, 0x40000
    s_cmp_ge_u32 s58, s73
    s_cselect_b32 s60, 0x380000, 0
    s_sub_u32 s58, s58, s60
    s_waitcnt lgkmcnt(10)
    v_mfma_f32_32x32x16_bf16 v[208:223], a[84:87], a[144:147], v[208:223]
    ds_read_b64_tr_b16 a[108:109], v41 offset:16384
    ds_read_b64_tr_b16 a[110:111], v41 offset:20480
    s_waitcnt lgkmcnt(10)
    v_mfma_f32_32x32x16_bf16 v[224:239], a[88:91], a[144:147], v[224:239]
    ds_read_b64_tr_b16 a[112:113], v38 offset:16640
    ds_read_b64_tr_b16 a[114:115], v38 offset:20736
    s_waitcnt lgkmcnt(10)
    v_mfma_f32_32x32x16_bf16 v[240:255], a[92:95], a[144:147], v[240:255]
    ds_read_b64_tr_b16 a[116:117], v39 offset:16640
    ds_read_b64_tr_b16 a[118:119], v39 offset:20736
    s_waitcnt lgkmcnt(10)
    v_mfma_f32_32x32x16_bf16 v[128:143], a[96:99], a[148:151], v[128:143]
    ds_read_b64_tr_b16 a[120:121], v40 offset:16640
    ds_read_b64_tr_b16 a[122:123], v40 offset:20736
    s_waitcnt lgkmcnt(10)
    v_mfma_f32_32x32x16_bf16 v[144:159], a[100:103], a[148:151], v[144:159]
    ds_read_b64_tr_b16 a[124:125], v41 offset:16640
    ds_read_b64_tr_b16 a[126:127], v41 offset:20736
    s_waitcnt lgkmcnt(10)
    v_mfma_f32_32x32x16_bf16 v[160:175], a[104:107], a[148:151], v[160:175]
    s_waitcnt lgkmcnt(8)
    v_mfma_f32_32x32x16_bf16 v[176:191], a[108:111], a[148:151], v[176:191]
    s_waitcnt lgkmcnt(6)
    v_mfma_f32_32x32x16_bf16 v[192:207], a[112:115], a[148:151], v[192:207]
    s_waitcnt lgkmcnt(4)
    v_mfma_f32_32x32x16_bf16 v[208:223], a[116:119], a[148:151], v[208:223]
    s_waitcnt lgkmcnt(0)
    s_waitcnt vmcnt(24)
    s_barrier
    v_add_u32 v42, 0x20000, v34
    v_add_u32 v43, 0x20000, v35
    v_add_u32 v44, 0x20000, v36
    v_add_u32 v45, 0x20000, v37
    ds_read_b64_tr_b16 a[64:65], v42 offset:0
    ds_read_b64_tr_b16 a[66:67], v42 offset:4096
    ds_read_b64_tr_b16 a[68:69], v43 offset:0
    ds_read_b64_tr_b16 a[70:71], v43 offset:4096
    ds_read_b64_tr_b16 a[72:73], v44 offset:0
    ds_read_b64_tr_b16 a[74:75], v44 offset:4096
    ds_read_b64_tr_b16 a[76:77], v45 offset:0
    ds_read_b64_tr_b16 a[78:79], v45 offset:4096
    s_add_u32 m0, s32, 0x18000
    s_nop 0
    buffer_load_dwordx4 v8, s[20:23], s58 offen offset:0 lds
    s_waitcnt lgkmcnt(10)
    v_mfma_f32_32x32x16_bf16 v[224:239], a[120:123], a[148:151], v[224:239]
    ds_read_b64_tr_b16 a[80:81], v42 offset:256
    ds_read_b64_tr_b16 a[82:83], v42 offset:4352
    buffer_load_dwordx4 v9, s[20:23], s58 offen offset:1024 lds
    s_waitcnt lgkmcnt(10)
    v_mfma_f32_32x32x16_bf16 v[240:255], a[124:127], a[148:151], v[240:255]
    ds_read_b64_tr_b16 a[84:85], v43 offset:256
    ds_read_b64_tr_b16 a[86:87], v43 offset:4352
    buffer_load_dwordx4 v10, s[20:23], s58 offen offset:2048 lds
    s_waitcnt lgkmcnt(10)
    v_mfma_f32_32x32x16_bf16 v[128:143], a[64:67], a[152:155], v[128:143]
    ds_read_b64_tr_b16 a[88:89], v44 offset:256
    ds_read_b64_tr_b16 a[90:91], v44 offset:4352
    buffer_load_dwordx4 v11, s[20:23], s58 offen offset:3072 lds
    s_waitcnt lgkmcnt(10)
    v_mfma_f32_32x32x16_bf16 v[144:159], a[68:71], a[152:155], v[144:159]
    ds_read_b64_tr_b16 a[92:93], v45 offset:256
    ds_read_b64_tr_b16 a[94:95], v45 offset:4352
    s_add_u32 m0, s32, 0x19000
    s_nop 0
    buffer_load_dwordx4 v68, s[20:23], s58 offen offset:0 lds
    s_waitcnt lgkmcnt(10)
    v_mfma_f32_32x32x16_bf16 v[160:175], a[72:75], a[152:155], v[160:175]
    ds_read_b64_tr_b16 a[96:97], v42 offset:16384
    ds_read_b64_tr_b16 a[98:99], v42 offset:20480
    buffer_load_dwordx4 v69, s[20:23], s58 offen offset:1024 lds
    s_waitcnt lgkmcnt(10)
    v_mfma_f32_32x32x16_bf16 v[176:191], a[76:79], a[152:155], v[176:191]
    ds_read_b64_tr_b16 a[100:101], v43 offset:16384
    ds_read_b64_tr_b16 a[102:103], v43 offset:20480
    buffer_load_dwordx4 v70, s[20:23], s58 offen offset:2048 lds
    s_waitcnt lgkmcnt(10)
    v_mfma_f32_32x32x16_bf16 v[192:207], a[80:83], a[152:155], v[192:207]
    ds_read_b64_tr_b16 a[104:105], v44 offset:16384
    ds_read_b64_tr_b16 a[106:107], v44 offset:20480
    buffer_load_dwordx4 v71, s[20:23], s58 offen offset:3072 lds
    s_add_u32 s58, s58, 0x40000
    s_cmp_ge_u32 s58, s73
    s_cselect_b32 s60, 0x380000, 0
    s_sub_u32 s58, s58, s60
    s_waitcnt lgkmcnt(10)
    v_mfma_f32_32x32x16_bf16 v[208:223], a[84:87], a[152:155], v[208:223]
    ds_read_b64_tr_b16 a[108:109], v45 offset:16384
    ds_read_b64_tr_b16 a[110:111], v45 offset:20480
    s_waitcnt lgkmcnt(10)
    v_mfma_f32_32x32x16_bf16 v[224:239], a[88:91], a[152:155], v[224:239]
    ds_read_b64_tr_b16 a[112:113], v42 offset:16640
    ds_read_b64_tr_b16 a[114:115], v42 offset:20736
    s_waitcnt lgkmcnt(10)
    v_mfma_f32_32x32x16_bf16 v[240:255], a[92:95], a[152:155], v[240:255]
    ds_read_b64_tr_b16 a[116:117], v43 offset:16640
    ds_read_b64_tr_b16 a[118:119], v43 offset:20736
    s_waitcnt lgkmcnt(10)
    v_mfma_f32_32x32x16_bf16 v[128:143], a[96:99], a[156:159], v[128:143]
    ds_read_b64_tr_b16 a[120:121], v44 offset:16640
    ds_read_b64_tr_b16 a[122:123], v44 offset:20736
    s_waitcnt lgkmcnt(10)
    v_mfma_f32_32x32x16_bf16 v[144:159], a[100:103], a[156:159], v[144:159]
    ds_read_b64_tr_b16 a[124:125], v45 offset:16640
    ds_read_b64_tr_b16 a[126:127], v45 offset:20736
    s_waitcnt lgkmcnt(10)
    v_mfma_f32_32x32x16_bf16 v[160:175], a[104:107], a[156:159], v[160:175]
    s_waitcnt lgkmcnt(8)
    v_mfma_f32_32x32x16_bf16 v[176:191], a[108:111], a[156:159], v[176:191]
    s_waitcnt lgkmcnt(6)
    v_mfma_f32_32x32x16_bf16 v[192:207], a[112:115], a[156:159], v[192:207]
    s_waitcnt lgkmcnt(4)
    v_mfma_f32_32x32x16_bf16 v[208:223], a[116:119], a[156:159], v[208:223]
    s_waitcnt lgkmcnt(0)
    s_waitcnt vmcnt(24)
    s_barrier
    v_add_u32 v38, 0x0, v34
    v_add_u32 v39, 0x0, v35
    v_add_u32 v40, 0x0, v36
    v_add_u32 v41, 0x0, v37
    ds_read_b64_tr_b16 a[64:65], v38 offset:0
    ds_read_b64_tr_b16 a[66:67], v38 offset:4096
    ds_read_b64_tr_b16 a[68:69], v39 offset:0
    ds_read_b64_tr_b16 a[70:71], v39 offset:4096
    ds_read_b64_tr_b16 a[72:73], v40 offset:0
    ds_read_b64_tr_b16 a[74:75], v40 offset:4096
    ds_read_b64_tr_b16 a[76:77], v41 offset:0
    ds_read_b64_tr_b16 a[78:79], v41 offset:4096
    s_add_u32 m0, s32, 0x20000
    s_nop 0
    buffer_load_dwordx4 v8, s[20:23], s58 offen offset:0 lds
    s_waitcnt lgkmcnt(10)
    v_mfma_f32_32x32x16_bf16 v[224:239], a[120:123], a[156:159], v[224:239]
    ds_read_b64_tr_b16 a[80:81], v38 offset:256
    ds_read_b64_tr_b16 a[82:83], v38 offset:4352
    buffer_load_dwordx4 v9, s[20:23], s58 offen offset:1024 lds
    s_waitcnt lgkmcnt(10)
    v_mfma_f32_32x32x16_bf16 v[240:255], a[124:127], a[156:159], v[240:255]
    ds_read_b64_tr_b16 a[84:85], v39 offset:256
    ds_read_b64_tr_b16 a[86:87], v39 offset:4352
    buffer_load_dwordx4 v10, s[20:23], s58 offen offset:2048 lds
    s_waitcnt lgkmcnt(10)
    v_mfma_f32_32x32x16_bf16 v[128:143], a[64:67], a[160:163], v[128:143]
    ds_read_b64_tr_b16 a[88:89], v40 offset:256
    ds_read_b64_tr_b16 a[90:91], v40 offset:4352
    buffer_load_dwordx4 v11, s[20:23], s58 offen offset:3072 lds
    s_waitcnt lgkmcnt(10)
    v_mfma_f32_32x32x16_bf16 v[144:159], a[68:71], a[160:163], v[144:159]
    ds_read_b64_tr_b16 a[92:93], v41 offset:256
    ds_read_b64_tr_b16 a[94:95], v41 offset:4352
    s_add_u32 m0, s32, 0x21000
    s_nop 0
    buffer_load_dwordx4 v68, s[20:23], s58 offen offset:0 lds
    s_waitcnt lgkmcnt(10)
    v_mfma_f32_32x32x16_bf16 v[160:175], a[72:75], a[160:163], v[160:175]
    ds_read_b64_tr_b16 a[96:97], v38 offset:16384
    ds_read_b64_tr_b16 a[98:99], v38 offset:20480
    buffer_load_dwordx4 v69, s[20:23], s58 offen offset:1024 lds
    s_waitcnt lgkmcnt(10)
    v_mfma_f32_32x32x16_bf16 v[176:191], a[76:79], a[160:163], v[176:191]
    ds_read_b64_tr_b16 a[100:101], v39 offset:16384
    ds_read_b64_tr_b16 a[102:103], v39 offset:20480
    buffer_load_dwordx4 v70, s[20:23], s58 offen offset:2048 lds
    s_waitcnt lgkmcnt(10)
    v_mfma_f32_32x32x16_bf16 v[192:207], a[80:83], a[160:163], v[192:207]
    ds_read_b64_tr_b16 a[104:105], v40 offset:16384
    ds_read_b64_tr_b16 a[106:107], v40 offset:20480
    buffer_load_dwordx4 v71, s[20:23], s58 offen offset:3072 lds
    s_add_u32 s58, s58, 0x40000
    s_cmp_ge_u32 s58, s73
    s_cselect_b32 s60, 0x380000, 0
    s_sub_u32 s58, s58, s60
    s_waitcnt lgkmcnt(10)
    v_mfma_f32_32x32x16_bf16 v[208:223], a[84:87], a[160:163], v[208:223]
    ds_read_b64_tr_b16 a[108:109], v41 offset:16384
    ds_read_b64_tr_b16 a[110:111], v41 offset:20480
    s_waitcnt lgkmcnt(10)
    v_mfma_f32_32x32x16_bf16 v[224:239], a[88:91], a[160:163], v[224:239]
    ds_read_b64_tr_b16 a[112:113], v38 offset:16640
    ds_read_b64_tr_b16 a[114:115], v38 offset:20736
    s_waitcnt lgkmcnt(10)
    v_mfma_f32_32x32x16_bf16 v[240:255], a[92:95], a[160:163], v[240:255]
    ds_read_b64_tr_b16 a[116:117], v39 offset:16640
    ds_read_b64_tr_b16 a[118:119], v39 offset:20736
    s_waitcnt lgkmcnt(10)
    v_mfma_f32_32x32x16_bf16 v[128:143], a[96:99], a[164:167], v[128:143]
    ds_read_b64_tr_b16 a[120:121], v40 offset:16640
    ds_read_b64_tr_b16 a[122:123], v40 offset:20736
    s_waitcnt lgkmcnt(10)
    v_mfma_f32_32x32x16_bf16 v[144:159], a[100:103], a[164:167], v[144:159]
    ds_read_b64_tr_b16 a[124:125], v41 offset:16640
    ds_read_b64_tr_b16 a[126:127], v41 offset:20736
    s_waitcnt lgkmcnt(10)
    v_mfma_f32_32x32x16_bf16 v[160:175], a[104:107], a[164:167], v[160:175]
    s_waitcnt lgkmcnt(8)
    v_mfma_f32_32x32x16_bf16 v[176:191], a[108:111], a[164:167], v[176:191]
    s_waitcnt lgkmcnt(6)
    v_mfma_f32_32x32x16_bf16 v[192:207], a[112:115], a[164:167], v[192:207]
    s_waitcnt lgkmcnt(4)
    v_mfma_f32_32x32x16_bf16 v[208:223], a[116:119], a[164:167], v[208:223]
    s_waitcnt lgkmcnt(0)
    s_waitcnt vmcnt(24)
    s_barrier
    v_add_u32 v42, 0x8000, v34
    v_add_u32 v43, 0x8000, v35
    v_add_u32 v44, 0x8000, v36
    v_add_u32 v45, 0x8000, v37
    ds_read_b64_tr_b16 a[64:65], v42 offset:0
    ds_read_b64_tr_b16 a[66:67], v42 offset:4096
    ds_read_b64_tr_b16 a[68:69], v43 offset:0
    ds_read_b64_tr_b16 a[70:71], v43 offset:4096
    ds_read_b64_tr_b16 a[72:73], v44 offset:0
    ds_read_b64_tr_b16 a[74:75], v44 offset:4096
    ds_read_b64_tr_b16 a[76:77], v45 offset:0
    ds_read_b64_tr_b16 a[78:79], v45 offset:4096
    s_add_u32 m0, s32, 0x0
    s_nop 0
    buffer_load_dwordx4 v8, s[20:23], s58 offen offset:0 lds
    s_waitcnt lgkmcnt(10)
    v_mfma_f32_32x32x16_bf16 v[224:239], a[120:123], a[164:167], v[224:239]
    ds_read_b64_tr_b16 a[80:81], v42 offset:256
    ds_read_b64_tr_b16 a[82:83], v42 offset:4352
    buffer_load_dwordx4 v9, s[20:23], s58 offen offset:1024 lds
    s_waitcnt lgkmcnt(10)
    v_mfma_f32_32x32x16_bf16 v[240:255], a[124:127], a[164:167], v[240:255]
    ds_read_b64_tr_b16 a[84:85], v43 offset:256
    ds_read_b64_tr_b16 a[86:87], v43 offset:4352
    buffer_load_dwordx4 v10, s[20:23], s58 offen offset:2048 lds
    s_waitcnt lgkmcnt(10)
    v_mfma_f32_32x32x16_bf16 v[128:143], a[64:67], a[168:171], v[128:143]
    ds_read_b64_tr_b16 a[88:89], v44 offset:256
    ds_read_b64_tr_b16 a[90:91], v44 offset:4352
    buffer_load_dwordx4 v11, s[20:23], s58 offen offset:3072 lds
    s_waitcnt lgkmcnt(10)
    v_mfma_f32_32x32x16_bf16 v[144:159], a[68:71], a[168:171], v[144:159]
    ds_read_b64_tr_b16 a[92:93], v45 offset:256
    ds_read_b64_tr_b16 a[94:95], v45 offset:4352
    s_add_u32 m0, s32, 0x1000
    s_nop 0
    buffer_load_dwordx4 v68, s[20:23], s58 offen offset:0 lds
    s_waitcnt lgkmcnt(10)
    v_mfma_f32_32x32x16_bf16 v[160:175], a[72:75], a[168:171], v[160:175]
    ds_read_b64_tr_b16 a[96:97], v42 offset:16384
    ds_read_b64_tr_b16 a[98:99], v42 offset:20480
    buffer_load_dwordx4 v69, s[20:23], s58 offen offset:1024 lds
    s_waitcnt lgkmcnt(10)
    v_mfma_f32_32x32x16_bf16 v[176:191], a[76:79], a[168:171], v[176:191]
    ds_read_b64_tr_b16 a[100:101], v43 offset:16384
    ds_read_b64_tr_b16 a[102:103], v43 offset:20480
    buffer_load_dwordx4 v70, s[20:23], s58 offen offset:2048 lds
    s_waitcnt lgkmcnt(10)
    v_mfma_f32_32x32x16_bf16 v[192:207], a[80:83], a[168:171], v[192:207]
    ds_read_b64_tr_b16 a[104:105], v44 offset:16384
    ds_read_b64_tr_b16 a[106:107], v44 offset:20480
    buffer_load_dwordx4 v71, s[20:23], s58 offen offset:3072 lds
    s_add_u32 s58, s58, 0x40000
    s_cmp_ge_u32 s58, s73
    s_cselect_b32 s60, 0x380000, 0
    s_sub_u32 s58, s58, s60
    s_waitcnt lgkmcnt(10)
    v_mfma_f32_32x32x16_bf16 v[208:223], a[84:87], a[168:171], v[208:223]
    ds_read_b64_tr_b16 a[108:109], v45 offset:16384
    ds_read_b64_tr_b16 a[110:111], v45 offset:20480
    s_waitcnt lgkmcnt(10)
    v_mfma_f32_32x32x16_bf16 v[224:239], a[88:91], a[168:171], v[224:239]
    ds_read_b64_tr_b16 a[112:113], v42 offset:16640
    ds_read_b64_tr_b16 a[114:115], v42 offset:20736
    s_waitcnt lgkmcnt(10)
    v_mfma_f32_32x32x16_bf16 v[240:255], a[92:95], a[168:171], v[240:255]
    ds_read_b64_tr_b16 a[116:117], v43 offset:16640
    ds_read_b64_tr_b16 a[118:119], v43 offset:20736
    s_waitcnt lgkmcnt(10)
    v_mfma_f32_32x32x16_bf16 v[128:143], a[96:99], a[172:175], v[128:143]
    ds_read_b64_tr_b16 a[120:121], v44 offset:16640
    ds_read_b64_tr_b16 a[122:123], v44 offset:20736
    s_waitcnt lgkmcnt(10)
    v_mfma_f32_32x32x16_bf16 v[144:159], a[100:103], a[172:175], v[144:159]
    ds_read_b64_tr_b16 a[124:125], v45 offset:16640
    ds_read_b64_tr_b16 a[126:127], v45 offset:20736
    s_waitcnt lgkmcnt(10)
    v_mfma_f32_32x32x16_bf16 v[160:175], a[104:107], a[172:175], v[160:175]
    s_waitcnt lgkmcnt(8)
    v_mfma_f32_32x32x16_bf16 v[176:191], a[108:111], a[172:175], v[176:191]
    s_waitcnt lgkmcnt(6)
    v_mfma_f32_32x32x16_bf16 v[192:207], a[112:115], a[172:175], v[192:207]
    s_waitcnt lgkmcnt(4)
    v_mfma_f32_32x32x16_bf16 v[208:223], a[116:119], a[172:175], v[208:223]
    s_waitcnt lgkmcnt(0)
    s_waitcnt vmcnt(24)
    s_barrier
    v_add_u32 v38, 0x10000, v34
    v_add_u32 v39, 0x10000, v35
    v_add_u32 v40, 0x10000, v36
    v_add_u32 v41, 0x10000, v37
    ds_read_b64_tr_b16 a[64:65], v38 offset:0
    ds_read_b64_tr_b16 a[66:67], v38 offset:4096
    ds_read_b64_tr_b16 a[68:69], v39 offset:0
    ds_read_b64_tr_b16 a[70:71], v39 offset:4096
    ds_read_b64_tr_b16 a[72:73], v40 offset:0
    ds_read_b64_tr_b16 a[74:75], v40 offset:4096
    ds_read_b64_tr_b16 a[76:77], v41 offset:0
    ds_read_b64_tr_b16 a[78:79], v41 offset:4096
    s_add_u32 m0, s32, 0x8000
    s_nop 0
    buffer_load_dwordx4 v8, s[20:23], s58 offen offset:0 lds
    s_waitcnt lgkmcnt(10)
    v_mfma_f32_32x32x16_bf16 v[224:239], a[120:123], a[172:175], v[224:239]
    ds_read_b64_tr_b16 a[80:81], v38 offset:256
    ds_read_b64_tr_b16 a[82:83], v38 offset:4352
    buffer_load_dwordx4 v9, s[20:23], s58 offen offset:1024 lds
    s_waitcnt lgkmcnt(10)
    v_mfma_f32_32x32x16_bf16 v[240:255], a[124:127], a[172:175], v[240:255]
    ds_read_b64_tr_b16 a[84:85], v39 offset:256
    ds_read_b64_tr_b16 a[86:87], v39 offset:4352
    buffer_load_dwordx4 v10, s[20:23], s58 offen offset:2048 lds
    s_waitcnt lgkmcnt(10)
    v_mfma_f32_32x32x16_bf16 v[128:143], a[64:67], a[176:179], v[128:143]
    ds_read_b64_tr_b16 a[88:89], v40 offset:256
    ds_read_b64_tr_b16 a[90:91], v40 offset:4352
    buffer_load_dwordx4 v11, s[20:23], s58 offen offset:3072 lds
    s_waitcnt lgkmcnt(10)
    v_mfma_f32_32x32x16_bf16 v[144:159], a[68:71], a[176:179], v[144:159]
    ds_read_b64_tr_b16 a[92:93], v41 offset:256
    ds_read_b64_tr_b16 a[94:95], v41 offset:4352
    s_add_u32 m0, s32, 0x9000
    s_nop 0
    buffer_load_dwordx4 v68, s[20:23], s58 offen offset:0 lds
    s_waitcnt lgkmcnt(10)
    v_mfma_f32_32x32x16_bf16 v[160:175], a[72:75], a[176:179], v[160:175]
    ds_read_b64_tr_b16 a[96:97], v38 offset:16384
    ds_read_b64_tr_b16 a[98:99], v38 offset:20480
    buffer_load_dwordx4 v69, s[20:23], s58 offen offset:1024 lds
    s_waitcnt lgkmcnt(10)
    v_mfma_f32_32x32x16_bf16 v[176:191], a[76:79], a[176:179], v[176:191]
    ds_read_b64_tr_b16 a[100:101], v39 offset:16384
    ds_read_b64_tr_b16 a[102:103], v39 offset:20480
    buffer_load_dwordx4 v70, s[20:23], s58 offen offset:2048 lds
    s_waitcnt lgkmcnt(10)
    v_mfma_f32_32x32x16_bf16 v[192:207], a[80:83], a[176:179], v[192:207]
    ds_read_b64_tr_b16 a[104:105], v40 offset:16384
    ds_read_b64_tr_b16 a[106:107], v40 offset:20480
    buffer_load_dwordx4 v71, s[20:23], s58 offen offset:3072 lds
    s_add_u32 s58, s58, 0x40000
    s_cmp_ge_u32 s58, s73
    s_cselect_b32 s60, 0x380000, 0
    s_sub_u32 s58, s58, s60
    s_waitcnt lgkmcnt(10)
    v_mfma_f32_32x32x16_bf16 v[208:223], a[84:87], a[176:179], v[208:223]
    ds_read_b64_tr_b16 a[108:109], v41 offset:16384
    ds_read_b64_tr_b16 a[110:111], v41 offset:20480
    s_waitcnt lgkmcnt(10)
    v_mfma_f32_32x32x16_bf16 v[224:239], a[88:91], a[176:179], v[224:239]
    ds_read_b64_tr_b16 a[112:113], v38 offset:16640
    ds_read_b64_tr_b16 a[114:115], v38 offset:20736
    s_waitcnt lgkmcnt(10)
    v_mfma_f32_32x32x16_bf16 v[240:255], a[92:95], a[176:179], v[240:255]
    ds_read_b64_tr_b16 a[116:117], v39 offset:16640
    ds_read_b64_tr_b16 a[118:119], v39 offset:20736
    s_waitcnt lgkmcnt(10)
    v_mfma_f32_32x32x16_bf16 v[128:143], a[96:99], a[180:183], v[128:143]
    ds_read_b64_tr_b16 a[120:121], v40 offset:16640
    ds_read_b64_tr_b16 a[122:123], v40 offset:20736
    s_waitcnt lgkmcnt(10)
    v_mfma_f32_32x32x16_bf16 v[144:159], a[100:103], a[180:183], v[144:159]
    ds_read_b64_tr_b16 a[124:125], v41 offset:16640
    ds_read_b64_tr_b16 a[126:127], v41 offset:20736
    s_waitcnt lgkmcnt(10)
    v_mfma_f32_32x32x16_bf16 v[160:175], a[104:107], a[180:183], v[160:175]
    s_waitcnt lgkmcnt(8)
    v_mfma_f32_32x32x16_bf16 v[176:191], a[108:111], a[180:183], v[176:191]
    s_waitcnt lgkmcnt(6)
    v_mfma_f32_32x32x16_bf16 v[192:207], a[112:115], a[180:183], v[192:207]
    s_waitcnt lgkmcnt(4)
    v_mfma_f32_32x32x16_bf16 v[208:223], a[116:119], a[180:183], v[208:223]
    s_waitcnt lgkmcnt(0)
    s_waitcnt vmcnt(24)
    s_barrier
    v_add_u32 v42, 0x18000, v34
    v_add_u32 v43, 0x18000, v35
    v_add_u32 v44, 0x18000, v36
    v_add_u32 v45, 0x18000, v37
    ds_read_b64_tr_b16 a[64:65], v42 offset:0
    ds_read_b64_tr_b16 a[66:67], v42 offset:4096
    ds_read_b64_tr_b16 a[68:69], v43 offset:0
    ds_read_b64_tr_b16 a[70:71], v43 offset:4096
    ds_read_b64_tr_b16 a[72:73], v44 offset:0
    ds_read_b64_tr_b16 a[74:75], v44 offset:4096
    ds_read_b64_tr_b16 a[76:77], v45 offset:0
    ds_read_b64_tr_b16 a[78:79], v45 offset:4096
    s_add_u32 m0, s32, 0x10000
    s_nop 0
    buffer_load_dwordx4 v8, s[20:23], s58 offen offset:0 lds
    s_waitcnt lgkmcnt(10)
    v_mfma_f32_32x32x16_bf16 v[224:239], a[120:123], a[180:183], v[224:239]
    ds_read_b64_tr_b16 a[80:81], v42 offset:256
    ds_read_b64_tr_b16 a[82:83], v42 offset:4352
    buffer_load_dwordx4 v9, s[20:23], s58 offen offset:1024 lds
    s_waitcnt lgkmcnt(10)
    v_mfma_f32_32x32x16_bf16 v[240:255], a[124:127], a[180:183], v[240:255]
    ds_read_b64_tr_b16 a[84:85], v43 offset:256
    ds_read_b64_tr_b16 a[86:87], v43 offset:4352
    buffer_load_dwordx4 v10, s[20:23], s58 offen offset:2048 lds
    s_waitcnt lgkmcnt(10)
    v_mfma_f32_32x32x16_bf16 v[128:143], a[64:67], a[184:187], v[128:143]
    ds_read_b64_tr_b16 a[88:89], v44 offset:256
    ds_read_b64_tr_b16 a[90:91], v44 offset:4352
    buffer_load_dwordx4 v11, s[20:23], s58 offen offset:3072 lds
    s_waitcnt lgkmcnt(10)
    v_mfma_f32_32x32x16_bf16 v[144:159], a[68:71], a[184:187], v[144:159]
    ds_read_b64_tr_b16 a[92:93], v45 offset:256
    ds_read_b64_tr_b16 a[94:95], v45 offset:4352
    s_add_u32 m0, s32, 0x11000
    s_nop 0
    buffer_load_dwordx4 v68, s[20:23], s58 offen offset:0 lds
    s_waitcnt lgkmcnt(10)
    v_mfma_f32_32x32x16_bf16 v[160:175], a[72:75], a[184:187], v[160:175]
    ds_read_b64_tr_b16 a[96:97], v42 offset:16384
    ds_read_b64_tr_b16 a[98:99], v42 offset:20480
    buffer_load_dwordx4 v69, s[20:23], s58 offen offset:1024 lds
    s_waitcnt lgkmcnt(10)
    v_mfma_f32_32x32x16_bf16 v[176:191], a[76:79], a[184:187], v[176:191]
    ds_read_b64_tr_b16 a[100:101], v43 offset:16384
    ds_read_b64_tr_b16 a[102:103], v43 offset:20480
    buffer_load_dwordx4 v70, s[20:23], s58 offen offset:2048 lds
    s_waitcnt lgkmcnt(10)
    v_mfma_f32_32x32x16_bf16 v[192:207], a[80:83], a[184:187], v[192:207]
    ds_read_b64_tr_b16 a[104:105], v44 offset:16384
    ds_read_b64_tr_b16 a[106:107], v44 offset:20480
    buffer_load_dwordx4 v71, s[20:23], s58 offen offset:3072 lds
    s_add_u32 s58, s58, 0x40000
    s_cmp_ge_u32 s58, s73
    s_cselect_b32 s60, 0x380000, 0
    s_sub_u32 s58, s58, s60
    s_waitcnt lgkmcnt(10)
    v_mfma_f32_32x32x16_bf16 v[208:223], a[84:87], a[184:187], v[208:223]
    ds_read_b64_tr_b16 a[108:109], v45 offset:16384
    ds_read_b64_tr_b16 a[110:111], v45 offset:20480
    s_waitcnt lgkmcnt(10)
    v_mfma_f32_32x32x16_bf16 v[224:239], a[88:91], a[184:187], v[224:239]
    ds_read_b64_tr_b16 a[112:113], v42 offset:16640
    ds_read_b64_tr_b16 a[114:115], v42 offset:20736
    s_waitcnt lgkmcnt(10)
    v_mfma_f32_32x32x16_bf16 v[240:255], a[92:95], a[184:187], v[240:255]
    ds_read_b64_tr_b16 a[116:117], v43 offset:16640
    ds_read_b64_tr_b16 a[118:119], v43 offset:20736
    s_waitcnt lgkmcnt(10)
    v_mfma_f32_32x32x16_bf16 v[128:143], a[96:99], a[188:191], v[128:143]
    ds_read_b64_tr_b16 a[120:121], v44 offset:16640
    ds_read_b64_tr_b16 a[122:123], v44 offset:20736
    s_waitcnt lgkmcnt(10)
    v_mfma_f32_32x32x16_bf16 v[144:159], a[100:103], a[188:191], v[144:159]
    ds_read_b64_tr_b16 a[124:125], v45 offset:16640
    ds_read_b64_tr_b16 a[126:127], v45 offset:20736
    s_waitcnt lgkmcnt(10)
    v_mfma_f32_32x32x16_bf16 v[160:175], a[104:107], a[188:191], v[160:175]
    s_waitcnt lgkmcnt(8)
    v_mfma_f32_32x32x16_bf16 v[176:191], a[108:111], a[188:191], v[176:191]
    s_waitcnt lgkmcnt(6)
    v_mfma_f32_32x32x16_bf16 v[192:207], a[112:115], a[188:191], v[192:207]
    s_waitcnt lgkmcnt(4)
    v_mfma_f32_32x32x16_bf16 v[208:223], a[116:119], a[188:191], v[208:223]
    s_waitcnt lgkmcnt(0)
    s_waitcnt vmcnt(24)
    s_barrier
    v_add_u32 v38, 0x20000, v34
    v_add_u32 v39, 0x20000, v35
    v_add_u32 v40, 0x20000, v36
    v_add_u32 v41, 0x20000, v37
    ds_read_b64_tr_b16 a[64:65], v38 offset:0
    ds_read_b64_tr_b16 a[66:67], v38 offset:4096
    ds_read_b64_tr_b16 a[68:69], v39 offset:0
    ds_read_b64_tr_b16 a[70:71], v39 offset:4096
    ds_read_b64_tr_b16 a[72:73], v40 offset:0
    ds_read_b64_tr_b16 a[74:75], v40 offset:4096
    ds_read_b64_tr_b16 a[76:77], v41 offset:0
    ds_read_b64_tr_b16 a[78:79], v41 offset:4096
    s_add_u32 m0, s32, 0x18000
    s_nop 0
    buffer_load_dwordx4 v8, s[20:23], s58 offen offset:0 lds
    s_waitcnt lgkmcnt(10)
    v_mfma_f32_32x32x16_bf16 v[224:239], a[120:123], a[188:191], v[224:239]
    ds_read_b64_tr_b16 a[80:81], v38 offset:256
    ds_read_b64_tr_b16 a[82:83], v38 offset:4352
    buffer_load_dwordx4 v9, s[20:23], s58 offen offset:1024 lds
    s_waitcnt lgkmcnt(10)
    v_mfma_f32_32x32x16_bf16 v[240:255], a[124:127], a[188:191], v[240:255]
    ds_read_b64_tr_b16 a[84:85], v39 offset:256
    ds_read_b64_tr_b16 a[86:87], v39 offset:4352
    buffer_load_dwordx4 v10, s[20:23], s58 offen offset:2048 lds
    s_waitcnt lgkmcnt(10)
    v_mfma_f32_32x32x16_bf16 v[128:143], a[64:67], a[192:195], v[128:143]
    ds_read_b64_tr_b16 a[88:89], v40 offset:256
    ds_read_b64_tr_b16 a[90:91], v40 offset:4352
    buffer_load_dwordx4 v11, s[20:23], s58 offen offset:3072 lds
    s_waitcnt lgkmcnt(10)
    v_mfma_f32_32x32x16_bf16 v[144:159], a[68:71], a[192:195], v[144:159]
    ds_read_b64_tr_b16 a[92:93], v41 offset:256
    ds_read_b64_tr_b16 a[94:95], v41 offset:4352
    s_add_u32 m0, s32, 0x19000
    s_nop 0
    buffer_load_dwordx4 v68, s[20:23], s58 offen offset:0 lds
    s_waitcnt lgkmcnt(10)
    v_mfma_f32_32x32x16_bf16 v[160:175], a[72:75], a[192:195], v[160:175]
    ds_read_b64_tr_b16 a[96:97], v38 offset:16384
    ds_read_b64_tr_b16 a[98:99], v38 offset:20480
    buffer_load_dwordx4 v69, s[20:23], s58 offen offset:1024 lds
    s_waitcnt lgkmcnt(10)
    v_mfma_f32_32x32x16_bf16 v[176:191], a[76:79], a[192:195], v[176:191]
    ds_read_b64_tr_b16 a[100:101], v39 offset:16384
    ds_read_b64_tr_b16 a[102:103], v39 offset:20480
    buffer_load_dwordx4 v70, s[20:23], s58 offen offset:2048 lds
    s_waitcnt lgkmcnt(10)
    v_mfma_f32_32x32x16_bf16 v[192:207], a[80:83], a[192:195], v[192:207]
    ds_read_b64_tr_b16 a[104:105], v40 offset:16384
    ds_read_b64_tr_b16 a[106:107], v40 offset:20480
    buffer_load_dwordx4 v71, s[20:23], s58 offen offset:3072 lds
    s_add_u32 s58, s58, 0x40000
    s_cmp_ge_u32 s58, s73
    s_cselect_b32 s60, 0x380000, 0
    s_sub_u32 s58, s58, s60
    s_waitcnt lgkmcnt(10)
    v_mfma_f32_32x32x16_bf16 v[208:223], a[84:87], a[192:195], v[208:223]
    ds_read_b64_tr_b16 a[108:109], v41 offset:16384
    ds_read_b64_tr_b16 a[110:111], v41 offset:20480
    s_waitcnt lgkmcnt(10)
    v_mfma_f32_32x32x16_bf16 v[224:239], a[88:91], a[192:195], v[224:239]
    ds_read_b64_tr_b16 a[112:113], v38 offset:16640
    ds_read_b64_tr_b16 a[114:115], v38 offset:20736
    s_waitcnt lgkmcnt(10)
    v_mfma_f32_32x32x16_bf16 v[240:255], a[92:95], a[192:195], v[240:255]
    ds_read_b64_tr_b16 a[116:117], v39 offset:16640
    ds_read_b64_tr_b16 a[118:119], v39 offset:20736
    s_waitcnt lgkmcnt(10)
    v_mfma_f32_32x32x16_bf16 v[128:143], a[96:99], a[196:199], v[128:143]
    ds_read_b64_tr_b16 a[120:121], v40 offset:16640
    ds_read_b64_tr_b16 a[122:123], v40 offset:20736
    s_waitcnt lgkmcnt(10)
    v_mfma_f32_32x32x16_bf16 v[144:159], a[100:103], a[196:199], v[144:159]
    ds_read_b64_tr_b16 a[124:125], v41 offset:16640
    ds_read_b64_tr_b16 a[126:127], v41 offset:20736
    s_waitcnt lgkmcnt(10)
    v_mfma_f32_32x32x16_bf16 v[160:175], a[104:107], a[196:199], v[160:175]
    s_waitcnt lgkmcnt(8)
    v_mfma_f32_32x32x16_bf16 v[176:191], a[108:111], a[196:199], v[176:191]
    s_waitcnt lgkmcnt(6)
    v_mfma_f32_32x32x16_bf16 v[192:207], a[112:115], a[196:199], v[192:207]
    s_waitcnt lgkmcnt(4)
    v_mfma_f32_32x32x16_bf16 v[208:223], a[116:119], a[196:199], v[208:223]
    s_waitcnt lgkmcnt(0)
    s_waitcnt vmcnt(24)
    s_barrier
    v_add_u32 v42, 0x0, v34
    v_add_u32 v43, 0x0, v35
    v_add_u32 v44, 0x0, v36
    v_add_u32 v45, 0x0, v37
    ds_read_b64_tr_b16 a[64:65], v42 offset:0
    ds_read_b64_tr_b16 a[66:67], v42 offset:4096
    ds_read_b64_tr_b16 a[68:69], v43 offset:0
    ds_read_b64_tr_b16 a[70:71], v43 offset:4096
    ds_read_b64_tr_b16 a[72:73], v44 offset:0
    ds_read_b64_tr_b16 a[74:75], v44 offset:4096
    ds_read_b64_tr_b16 a[76:77], v45 offset:0
    ds_read_b64_tr_b16 a[78:79], v45 offset:4096
    s_add_u32 m0, s32, 0x20000
    s_nop 0
    buffer_load_dwordx4 v8, s[20:23], s58 offen offset:0 lds
    s_waitcnt lgkmcnt(10)
    v_mfma_f32_32x32x16_bf16 v[224:239], a[120:123], a[196:199], v[224:239]
    ds_read_b64_tr_b16 a[80:81], v42 offset:256
    ds_read_b64_tr_b16 a[82:83], v42 offset:4352
    buffer_load_dwordx4 v9, s[20:23], s58 offen offset:1024 lds
    s_waitcnt lgkmcnt(10)
    v_mfma_f32_32x32x16_bf16 v[240:255], a[124:127], a[196:199], v[240:255]
    ds_read_b64_tr_b16 a[84:85], v43 offset:256
    ds_read_b64_tr_b16 a[86:87], v43 offset:4352
    buffer_load_dwordx4 v10, s[20:23], s58 offen offset:2048 lds
    s_waitcnt lgkmcnt(10)
    v_mfma_f32_32x32x16_bf16 v[128:143], a[64:67], a[200:203], v[128:143]
    ds_read_b64_tr_b16 a[88:89], v44 offset:256
    ds_read_b64_tr_b16 a[90:91], v44 offset:4352
    buffer_load_dwordx4 v11, s[20:23], s58 offen offset:3072 lds
    s_waitcnt lgkmcnt(10)
    v_mfma_f32_32x32x16_bf16 v[144:159], a[68:71], a[200:203], v[144:159]
    ds_read_b64_tr_b16 a[92:93], v45 offset:256
    ds_read_b64_tr_b16 a[94:95], v45 offset:4352
    s_add_u32 m0, s32, 0x21000
    s_nop 0
    buffer_load_dwordx4 v68, s[20:23], s58 offen offset:0 lds
    s_waitcnt lgkmcnt(10)
    v_mfma_f32_32x32x16_bf16 v[160:175], a[72:75], a[200:203], v[160:175]
    ds_read_b64_tr_b16 a[96:97], v42 offset:16384
    ds_read_b64_tr_b16 a[98:99], v42 offset:20480
    buffer_load_dwordx4 v69, s[20:23], s58 offen offset:1024 lds
    s_waitcnt lgkmcnt(10)
    v_mfma_f32_32x32x16_bf16 v[176:191], a[76:79], a[200:203], v[176:191]
    ds_read_b64_tr_b16 a[100:101], v43 offset:16384
    ds_read_b64_tr_b16 a[102:103], v43 offset:20480
    buffer_load_dwordx4 v70, s[20:23], s58 offen offset:2048 lds
    s_waitcnt lgkmcnt(10)
    v_mfma_f32_32x32x16_bf16 v[192:207], a[80:83], a[200:203], v[192:207]
    ds_read_b64_tr_b16 a[104:105], v44 offset:16384
    ds_read_b64_tr_b16 a[106:107], v44 offset:20480
    buffer_load_dwordx4 v71, s[20:23], s58 offen offset:3072 lds
    s_add_u32 s58, s58, 0x40000
    s_cmp_ge_u32 s58, s73
    s_cselect_b32 s60, 0x380000, 0
    s_sub_u32 s58, s58, s60
    s_waitcnt lgkmcnt(10)
    v_mfma_f32_32x32x16_bf16 v[208:223], a[84:87], a[200:203], v[208:223]
    ds_read_b64_tr_b16 a[108:109], v45 offset:16384
    ds_read_b64_tr_b16 a[110:111], v45 offset:20480
    s_waitcnt lgkmcnt(10)
    v_mfma_f32_32x32x16_bf16 v[224:239], a[88:91], a[200:203], v[224:239]
    ds_read_b64_tr_b16 a[112:113], v42 offset:16640
    ds_read_b64_tr_b16 a[114:115], v42 offset:20736
    s_waitcnt lgkmcnt(10)
    v_mfma_f32_32x32x16_bf16 v[240:255], a[92:95], a[200:203], v[240:255]
    ds_read_b64_tr_b16 a[116:117], v43 offset:16640
    ds_read_b64_tr_b16 a[118:119], v43 offset:20736
    s_waitcnt lgkmcnt(10)
    v_mfma_f32_32x32x16_bf16 v[128:143], a[96:99], a[204:207], v[128:143]
    ds_read_b64_tr_b16 a[120:121], v44 offset:16640
    ds_read_b64_tr_b16 a[122:123], v44 offset:20736
    s_waitcnt lgkmcnt(10)
    v_mfma_f32_32x32x16_bf16 v[144:159], a[100:103], a[204:207], v[144:159]
    ds_read_b64_tr_b16 a[124:125], v45 offset:16640
    ds_read_b64_tr_b16 a[126:127], v45 offset:20736
    s_waitcnt lgkmcnt(10)
    v_mfma_f32_32x32x16_bf16 v[160:175], a[104:107], a[204:207], v[160:175]
    s_waitcnt lgkmcnt(8)
    v_mfma_f32_32x32x16_bf16 v[176:191], a[108:111], a[204:207], v[176:191]
    s_waitcnt lgkmcnt(6)
    v_mfma_f32_32x32x16_bf16 v[192:207], a[112:115], a[204:207], v[192:207]
    s_waitcnt lgkmcnt(4)
    v_mfma_f32_32x32x16_bf16 v[208:223], a[116:119], a[204:207], v[208:223]
    s_waitcnt lgkmcnt(0)
    s_waitcnt vmcnt(24)
    s_barrier
    v_add_u32 v38, 0x8000, v34
    v_add_u32 v39, 0x8000, v35
    v_add_u32 v40, 0x8000, v36
    v_add_u32 v41, 0x8000, v37
    ds_read_b64_tr_b16 a[64:65], v38 offset:0
    ds_read_b64_tr_b16 a[66:67], v38 offset:4096
    ds_read_b64_tr_b16 a[68:69], v39 offset:0
    ds_read_b64_tr_b16 a[70:71], v39 offset:4096
    ds_read_b64_tr_b16 a[72:73], v40 offset:0
    ds_read_b64_tr_b16 a[74:75], v40 offset:4096
    ds_read_b64_tr_b16 a[76:77], v41 offset:0
    ds_read_b64_tr_b16 a[78:79], v41 offset:4096
    s_add_u32 m0, s32, 0x0
    s_add_u32 s61, s33, 0x0
    buffer_load_dwordx4 v12, s[12:15], s61 offen offset:0 nt lds
    s_waitcnt lgkmcnt(10)
    v_mfma_f32_32x32x16_bf16 v[224:239], a[120:123], a[204:207], v[224:239]
    ds_read_b64_tr_b16 a[80:81], v38 offset:256
    ds_read_b64_tr_b16 a[82:83], v38 offset:4352
    buffer_load_dwordx4 v13, s[12:15], s61 offen offset:1024 nt lds
    s_waitcnt lgkmcnt(10)
    v_mfma_f32_32x32x16_bf16 v[240:255], a[124:127], a[204:207], v[240:255]
    ds_read_b64_tr_b16 a[84:85], v39 offset:256
    ds_read_b64_tr_b16 a[86:87], v39 offset:4352
    buffer_load_dwordx4 v14, s[12:15], s61 offen offset:2048 nt lds
    s_waitcnt lgkmcnt(10)
    v_mfma_f32_32x32x16_bf16 v[128:143], a[64:67], a[208:211], v[128:143]
    ds_read_b64_tr_b16 a[88:89], v40 offset:256
    ds_read_b64_tr_b16 a[90:91], v40 offset:4352
    buffer_load_dwordx4 v15, s[12:15], s61 offen offset:3072 nt lds
    s_waitcnt lgkmcnt(10)
    v_mfma_f32_32x32x16_bf16 v[144:159], a[68:71], a[208:211], v[144:159]
    ds_read_b64_tr_b16 a[92:93], v41 offset:256
    ds_read_b64_tr_b16 a[94:95], v41 offset:4352
    s_add_u32 m0, s32, 0x1000
    s_add_u32 s61, s33, 0x1000
    buffer_load_dwordx4 v16, s[12:15], s61 offen offset:0 nt lds
    s_waitcnt lgkmcnt(10)
    v_mfma_f32_32x32x16_bf16 v[160:175], a[72:75], a[208:211], v[160:175]
    ds_read_b64_tr_b16 a[96:97], v38 offset:16384
    ds_read_b64_tr_b16 a[98:99], v38 offset:20480
    buffer_load_dwordx4 v17, s[12:15], s61 offen offset:1024 nt lds
    s_waitcnt lgkmcnt(10)
    v_mfma_f32_32x32x16_bf16 v[176:191], a[76:79], a[208:211], v[176:191]
    ds_read_b64_tr_b16 a[100:101], v39 offset:16384
    ds_read_b64_tr_b16 a[102:103], v39 offset:20480
    buffer_load_dwordx4 v18, s[12:15], s61 offen offset:2048 nt lds
    s_waitcnt lgkmcnt(10)
    v_mfma_f32_32x32x16_bf16 v[192:207], a[80:83], a[208:211], v[192:207]
    ds_read_b64_tr_b16 a[104:105], v40 offset:16384
    ds_read_b64_tr_b16 a[106:107], v40 offset:20480
    buffer_load_dwordx4 v19, s[12:15], s61 offen offset:3072 nt lds
    s_waitcnt lgkmcnt(10)
    v_mfma_f32_32x32x16_bf16 v[208:223], a[84:87], a[208:211], v[208:223]
    ds_read_b64_tr_b16 a[108:109], v41 offset:16384
    ds_read_b64_tr_b16 a[110:111], v41 offset:20480
    s_waitcnt lgkmcnt(10)
    v_mfma_f32_32x32x16_bf16 v[224:239], a[88:91], a[208:211], v[224:239]
    ds_read_b64_tr_b16 a[112:113], v38 offset:16640
    ds_read_b64_tr_b16 a[114:115], v38 offset:20736
    s_waitcnt lgkmcnt(10)
    v_mfma_f32_32x32x16_bf16 v[240:255], a[92:95], a[208:211], v[240:255]
    ds_read_b64_tr_b16 a[116:117], v39 offset:16640
    ds_read_b64_tr_b16 a[118:119], v39 offset:20736
    s_waitcnt lgkmcnt(10)
    v_mfma_f32_32x32x16_bf16 v[128:143], a[96:99], a[212:215], v[128:143]
    ds_read_b64_tr_b16 a[120:121], v40 offset:16640
    ds_read_b64_tr_b16 a[122:123], v40 offset:20736
    s_waitcnt lgkmcnt(10)
    v_mfma_f32_32x32x16_bf16 v[144:159], a[100:103], a[212:215], v[144:159]
    ds_read_b64_tr_b16 a[124:125], v41 offset:16640
    ds_read_b64_tr_b16 a[126:127], v41 offset:20736
    s_waitcnt lgkmcnt(10)
    v_mfma_f32_32x32x16_bf16 v[160:175], a[104:107], a[212:215], v[160:175]
    s_waitcnt lgkmcnt(8)
    v_mfma_f32_32x32x16_bf16 v[176:191], a[108:111], a[212:215], v[176:191]
    s_waitcnt lgkmcnt(6)
    v_mfma_f32_32x32x16_bf16 v[192:207], a[112:115], a[212:215], v[192:207]
    s_waitcnt lgkmcnt(4)
    v_mfma_f32_32x32x16_bf16 v[208:223], a[116:119], a[212:215], v[208:223]
    s_waitcnt lgkmcnt(0)
    s_waitcnt vmcnt(24)
    s_barrier
    v_add_u32 v42, 0x10000, v34
    v_add_u32 v43, 0x10000, v35
    v_add_u32 v44, 0x10000, v36
    v_add_u32 v45, 0x10000, v37
    ds_read_b64_tr_b16 a[64:65], v42 offset:0
    ds_read_b64_tr_b16 a[66:67], v42 offset:4096
    ds_read_b64_tr_b16 a[68:69], v43 offset:0
    ds_read_b64_tr_b16 a[70:71], v43 offset:4096
    ds_read_b64_tr_b16 a[72:73], v44 offset:0
    ds_read_b64_tr_b16 a[74:75], v44 offset:4096
    ds_read_b64_tr_b16 a[76:77], v45 offset:0
    ds_read_b64_tr_b16 a[78:79], v45 offset:4096
    s_add_u32 m0, s32, 0x8000
    s_add_u32 s61, s33, 0x0
    buffer_load_dwordx4 v20, s[16:19], s61 offen offset:0 nt lds
    s_waitcnt lgkmcnt(10)
    v_mfma_f32_32x32x16_bf16 v[224:239], a[120:123], a[212:215], v[224:239]
    ds_read_b64_tr_b16 a[80:81], v42 offset:256
    ds_read_b64_tr_b16 a[82:83], v42 offset:4352
    buffer_load_dwordx4 v21, s[16:19], s61 offen offset:1024 nt lds
    s_waitcnt lgkmcnt(10)
    v_mfma_f32_32x32x16_bf16 v[240:255], a[124:127], a[212:215], v[240:255]
    ds_read_b64_tr_b16 a[84:85], v43 offset:256
    ds_read_b64_tr_b16 a[86:87], v43 offset:4352
    buffer_load_dwordx4 v20, s[16:19], s61 offen offset:2048 nt lds
    s_waitcnt lgkmcnt(10)
    v_mfma_f32_32x32x16_bf16 v[128:143], a[64:67], a[216:219], v[128:143]
    ds_read_b64_tr_b16 a[88:89], v44 offset:256
    ds_read_b64_tr_b16 a[90:91], v44 offset:4352
    buffer_load_dwordx4 v21, s[16:19], s61 offen offset:3072 nt lds
    s_waitcnt lgkmcnt(10)
    v_mfma_f32_32x32x16_bf16 v[144:159], a[68:71], a[216:219], v[144:159]
    ds_read_b64_tr_b16 a[92:93], v45 offset:256
    ds_read_b64_tr_b16 a[94:95], v45 offset:4352
    s_add_u32 m0, s32, 0x9000
    s_add_u32 s61, s33, 0x1000
    buffer_load_dwordx4 v20, s[16:19], s61 offen offset:0 nt lds
    s_waitcnt lgkmcnt(10)
    v_mfma_f32_32x32x16_bf16 v[160:175], a[72:75], a[216:219], v[160:175]
    ds_read_b64_tr_b16 a[96:97], v42 offset:16384
    ds_read_b64_tr_b16 a[98:99], v42 offset:20480
    buffer_load_dwordx4 v21, s[16:19], s61 offen offset:1024 nt lds
    s_waitcnt lgkmcnt(10)
    v_mfma_f32_32x32x16_bf16 v[176:191], a[76:79], a[216:219], v[176:191]
    ds_read_b64_tr_b16 a[100:101], v43 offset:16384
    ds_read_b64_tr_b16 a[102:103], v43 offset:20480
    buffer_load_dwordx4 v20, s[16:19], s61 offen offset:2048 nt lds
    s_waitcnt lgkmcnt(10)
    v_mfma_f32_32x32x16_bf16 v[192:207], a[80:83], a[216:219], v[192:207]
    ds_read_b64_tr_b16 a[104:105], v44 offset:16384
    ds_read_b64_tr_b16 a[106:107], v44 offset:20480
    buffer_load_dwordx4 v21, s[16:19], s61 offen offset:3072 nt lds
    s_waitcnt lgkmcnt(10)
    v_mfma_f32_32x32x16_bf16 v[208:223], a[84:87], a[216:219], v[208:223]
    ds_read_b64_tr_b16 a[108:109], v45 offset:16384
    ds_read_b64_tr_b16 a[110:111], v45 offset:20480
    s_waitcnt lgkmcnt(10)
    v_mfma_f32_32x32x16_bf16 v[224:239], a[88:91], a[216:219], v[224:239]
    ds_read_b64_tr_b16 a[112:113], v42 offset:16640
    ds_read_b64_tr_b16 a[114:115], v42 offset:20736
    s_waitcnt lgkmcnt(10)
    v_mfma_f32_32x32x16_bf16 v[240:255], a[92:95], a[216:219], v[240:255]
    ds_read_b64_tr_b16 a[116:117], v43 offset:16640
    ds_read_b64_tr_b16 a[118:119], v43 offset:20736
    s_waitcnt lgkmcnt(10)
    v_mfma_f32_32x32x16_bf16 v[128:143], a[96:99], a[220:223], v[128:143]
    ds_read_b64_tr_b16 a[120:121], v44 offset:16640
    ds_read_b64_tr_b16 a[122:123], v44 offset:20736
    s_waitcnt lgkmcnt(10)
    v_mfma_f32_32x32x16_bf16 v[144:159], a[100:103], a[220:223], v[144:159]
    ds_read_b64_tr_b16 a[124:125], v45 offset:16640
    ds_read_b64_tr_b16 a[126:127], v45 offset:20736
    s_waitcnt lgkmcnt(10)
    v_mfma_f32_32x32x16_bf16 v[160:175], a[104:107], a[220:223], v[160:175]
    s_waitcnt lgkmcnt(8)
    v_mfma_f32_32x32x16_bf16 v[176:191], a[108:111], a[220:223], v[176:191]
    s_waitcnt lgkmcnt(6)
    v_mfma_f32_32x32x16_bf16 v[192:207], a[112:115], a[220:223], v[192:207]
    s_waitcnt lgkmcnt(4)
    v_mfma_f32_32x32x16_bf16 v[208:223], a[116:119], a[220:223], v[208:223]
    s_waitcnt lgkmcnt(0)
    s_waitcnt vmcnt(24)
    s_barrier
    v_add_u32 v38, 0x18000, v34
    v_add_u32 v39, 0x18000, v35
    v_add_u32 v40, 0x18000, v36
    v_add_u32 v41, 0x18000, v37
    ds_read_b64_tr_b16 a[64:65], v38 offset:0
    ds_read_b64_tr_b16 a[66:67], v38 offset:4096
    ds_read_b64_tr_b16 a[68:69], v39 offset:0
    ds_read_b64_tr_b16 a[70:71], v39 offset:4096
    ds_read_b64_tr_b16 a[72:73], v40 offset:0
    ds_read_b64_tr_b16 a[74:75], v40 offset:4096
    ds_read_b64_tr_b16 a[76:77], v41 offset:0
    ds_read_b64_tr_b16 a[78:79], v41 offset:4096
    s_add_u32 m0, s32, 0x10000
    s_add_u32 s61, s33, 0x8000
    buffer_load_dwordx4 v12, s[12:15], s61 offen offset:0 nt lds
    s_waitcnt lgkmcnt(10)
    v_mfma_f32_32x32x16_bf16 v[224:239], a[120:123], a[220:223], v[224:239]
    ds_read_b64_tr_b16 a[80:81], v38 offset:256
    ds_read_b64_tr_b16 a[82:83], v38 offset:4352
    buffer_load_dwordx4 v13, s[12:15], s61 offen offset:1024 nt lds
    s_waitcnt lgkmcnt(10)
    v_mfma_f32_32x32x16_bf16 v[240:255], a[124:127], a[220:223], v[240:255]
    ds_read_b64_tr_b16 a[84:85], v39 offset:256
    ds_read_b64_tr_b16 a[86:87], v39 offset:4352
    buffer_load_dwordx4 v14, s[12:15], s61 offen offset:2048 nt lds
    s_waitcnt lgkmcnt(10)
    v_mfma_f32_32x32x16_bf16 v[128:143], a[64:67], a[224:227], v[128:143]
    ds_read_b64_tr_b16 a[88:89], v40 offset:256
    ds_read_b64_tr_b16 a[90:91], v40 offset:4352
    buffer_load_dwordx4 v15, s[12:15], s61 offen offset:3072 nt lds
    s_waitcnt lgkmcnt(10)
    v_mfma_f32_32x32x16_bf16 v[144:159], a[68:71], a[224:227], v[144:159]
    ds_read_b64_tr_b16 a[92:93], v41 offset:256
    ds_read_b64_tr_b16 a[94:95], v41 offset:4352
    s_add_u32 m0, s32, 0x11000
    s_add_u32 s61, s33, 0x9000
    buffer_load_dwordx4 v16, s[12:15], s61 offen offset:0 nt lds
    s_waitcnt lgkmcnt(10)
    v_mfma_f32_32x32x16_bf16 v[160:175], a[72:75], a[224:227], v[160:175]
    ds_read_b64_tr_b16 a[96:97], v38 offset:16384
    ds_read_b64_tr_b16 a[98:99], v38 offset:20480
    buffer_load_dwordx4 v17, s[12:15], s61 offen offset:1024 nt lds
    s_waitcnt lgkmcnt(10)
    v_mfma_f32_32x32x16_bf16 v[176:191], a[76:79], a[224:227], v[176:191]
    ds_read_b64_tr_b16 a[100:101], v39 offset:16384
    ds_read_b64_tr_b16 a[102:103], v39 offset:20480
    buffer_load_dwordx4 v18, s[12:15], s61 offen offset:2048 nt lds
    s_waitcnt lgkmcnt(10)
    v_mfma_f32_32x32x16_bf16 v[192:207], a[80:83], a[224:227], v[192:207]
    ds_read_b64_tr_b16 a[104:105], v40 offset:16384
    ds_read_b64_tr_b16 a[106:107], v40 offset:20480
    buffer_load_dwordx4 v19, s[12:15], s61 offen offset:3072 nt lds
    s_waitcnt lgkmcnt(10)
    v_mfma_f32_32x32x16_bf16 v[208:223], a[84:87], a[224:227], v[208:223]
    ds_read_b64_tr_b16 a[108:109], v41 offset:16384
    ds_read_b64_tr_b16 a[110:111], v41 offset:20480
    s_waitcnt lgkmcnt(10)
    v_mfma_f32_32x32x16_bf16 v[224:239], a[88:91], a[224:227], v[224:239]
    ds_read_b64_tr_b16 a[112:113], v38 offset:16640
    ds_read_b64_tr_b16 a[114:115], v38 offset:20736
    s_waitcnt lgkmcnt(10)
    v_mfma_f32_32x32x16_bf16 v[240:255], a[92:95], a[224:227], v[240:255]
    ds_read_b64_tr_b16 a[116:117], v39 offset:16640
    ds_read_b64_tr_b16 a[118:119], v39 offset:20736
    s_waitcnt lgkmcnt(10)
    v_mfma_f32_32x32x16_bf16 v[128:143], a[96:99], a[228:231], v[128:143]
    ds_read_b64_tr_b16 a[120:121], v40 offset:16640
    ds_read_b64_tr_b16 a[122:123], v40 offset:20736
    s_waitcnt lgkmcnt(10)
    v_mfma_f32_32x32x16_bf16 v[144:159], a[100:103], a[228:231], v[144:159]
    ds_read_b64_tr_b16 a[124:125], v41 offset:16640
    ds_read_b64_tr_b16 a[126:127], v41 offset:20736
    s_waitcnt lgkmcnt(10)
    v_mfma_f32_32x32x16_bf16 v[160:175], a[104:107], a[228:231], v[160:175]
    s_waitcnt lgkmcnt(8)
    v_mfma_f32_32x32x16_bf16 v[176:191], a[108:111], a[228:231], v[176:191]
    s_waitcnt lgkmcnt(6)
    v_mfma_f32_32x32x16_bf16 v[192:207], a[112:115], a[228:231], v[192:207]
    s_waitcnt lgkmcnt(4)
    v_mfma_f32_32x32x16_bf16 v[208:223], a[116:119], a[228:231], v[208:223]
    s_waitcnt lgkmcnt(0)
    s_waitcnt vmcnt(24)
    s_barrier
    v_add_u32 v42, 0x20000, v34
    v_add_u32 v43, 0x20000, v35
    v_add_u32 v44, 0x20000, v36
    v_add_u32 v45, 0x20000, v37
    ds_read_b64_tr_b16 a[64:65], v42 offset:0
    ds_read_b64_tr_b16 a[66:67], v42 offset:4096
    ds_read_b64_tr_b16 a[68:69], v43 offset:0
    ds_read_b64_tr_b16 a[70:71], v43 offset:4096
    ds_read_b64_tr_b16 a[72:73], v44 offset:0
    ds_read_b64_tr_b16 a[74:75], v44 offset:4096
    ds_read_b64_tr_b16 a[76:77], v45 offset:0
    ds_read_b64_tr_b16 a[78:79], v45 offset:4096
    s_add_u32 m0, s32, 0x18000
    s_add_u32 s61, s33, 0x8000
    buffer_load_dwordx4 v20, s[16:19], s61 offen offset:0 nt lds
    s_waitcnt lgkmcnt(10)
    v_mfma_f32_32x32x16_bf16 v[224:239], a[120:123], a[228:231], v[224:239]
    ds_read_b64_tr_b16 a[80:81], v42 offset:256
    ds_read_b64_tr_b16 a[82:83], v42 offset:4352
    buffer_load_dwordx4 v21, s[16:19], s61 offen offset:1024 nt lds
    s_waitcnt lgkmcnt(10)
    v_mfma_f32_32x32x16_bf16 v[240:255], a[124:127], a[228:231], v[240:255]
    ds_read_b64_tr_b16 a[84:85], v43 offset:256
    ds_read_b64_tr_b16 a[86:87], v43 offset:4352
    buffer_load_dwordx4 v20, s[16:19], s61 offen offset:2048 nt lds
    s_waitcnt lgkmcnt(10)
    v_mfma_f32_32x32x16_bf16 v[128:143], a[64:67], a[232:235], v[128:143]
    ds_read_b64_tr_b16 a[88:89], v44 offset:256
    ds_read_b64_tr_b16 a[90:91], v44 offset:4352
    buffer_load_dwordx4 v21, s[16:19], s61 offen offset:3072 nt lds
    s_waitcnt lgkmcnt(10)
    v_mfma_f32_32x32x16_bf16 v[144:159], a[68:71], a[232:235], v[144:159]
    ds_read_b64_tr_b16 a[92:93], v45 offset:256
    ds_read_b64_tr_b16 a[94:95], v45 offset:4352
    s_add_u32 m0, s32, 0x19000
    s_add_u32 s61, s33, 0x9000
    buffer_load_dwordx4 v20, s[16:19], s61 offen offset:0 nt lds
    s_waitcnt lgkmcnt(10)
    v_mfma_f32_32x32x16_bf16 v[160:175], a[72:75], a[232:235], v[160:175]
    ds_read_b64_tr_b16 a[96:97], v42 offset:16384
    ds_read_b64_tr_b16 a[98:99], v42 offset:20480
    buffer_load_dwordx4 v21, s[16:19], s61 offen offset:1024 nt lds
    s_waitcnt lgkmcnt(10)
    v_mfma_f32_32x32x16_bf16 v[176:191], a[76:79], a[232:235], v[176:191]
    ds_read_b64_tr_b16 a[100:101], v43 offset:16384
    ds_read_b64_tr_b16 a[102:103], v43 offset:20480
    buffer_load_dwordx4 v20, s[16:19], s61 offen offset:2048 nt lds
    s_waitcnt lgkmcnt(10)
    v_mfma_f32_32x32x16_bf16 v[192:207], a[80:83], a[232:235], v[192:207]
    ds_read_b64_tr_b16 a[104:105], v44 offset:16384
    ds_read_b64_tr_b16 a[106:107], v44 offset:20480
    buffer_load_dwordx4 v21, s[16:19], s61 offen offset:3072 nt lds
    s_waitcnt lgkmcnt(10)
    v_mfma_f32_32x32x16_bf16 v[208:223], a[84:87], a[232:235], v[208:223]
    ds_read_b64_tr_b16 a[108:109], v45 offset:16384
    ds_read_b64_tr_b16 a[110:111], v45 offset:20480
    s_waitcnt lgkmcnt(10)
    v_mfma_f32_32x32x16_bf16 v[224:239], a[88:91], a[232:235], v[224:239]
    ds_read_b64_tr_b16 a[112:113], v42 offset:16640
    ds_read_b64_tr_b16 a[114:115], v42 offset:20736
    s_waitcnt lgkmcnt(10)
    v_mfma_f32_32x32x16_bf16 v[240:255], a[92:95], a[232:235], v[240:255]
    ds_read_b64_tr_b16 a[116:117], v43 offset:16640
    ds_read_b64_tr_b16 a[118:119], v43 offset:20736
    s_waitcnt lgkmcnt(10)
    v_mfma_f32_32x32x16_bf16 v[128:143], a[96:99], a[236:239], v[128:143]
    ds_read_b64_tr_b16 a[120:121], v44 offset:16640
    ds_read_b64_tr_b16 a[122:123], v44 offset:20736
    s_waitcnt lgkmcnt(10)
    v_mfma_f32_32x32x16_bf16 v[144:159], a[100:103], a[236:239], v[144:159]
    ds_read_b64_tr_b16 a[124:125], v45 offset:16640
    ds_read_b64_tr_b16 a[126:127], v45 offset:20736
    s_waitcnt lgkmcnt(10)
    v_mfma_f32_32x32x16_bf16 v[160:175], a[104:107], a[236:239], v[160:175]
    s_waitcnt lgkmcnt(8)
    v_mfma_f32_32x32x16_bf16 v[176:191], a[108:111], a[236:239], v[176:191]
    s_waitcnt lgkmcnt(6)
    v_mfma_f32_32x32x16_bf16 v[192:207], a[112:115], a[236:239], v[192:207]
    s_waitcnt lgkmcnt(4)
    v_mfma_f32_32x32x16_bf16 v[208:223], a[116:119], a[236:239], v[208:223]
    s_waitcnt lgkmcnt(2)
    v_mfma_f32_32x32x16_bf16 v[224:239], a[120:123], a[236:239], v[224:239]
    s_waitcnt lgkmcnt(0)
    v_mfma_f32_32x32x16_bf16 v[240:255], a[124:127], a[236:239], v[240:255]
    s_nop 15
    v_cvt_pk_bf16_f32 v96, v128, v129
    v_cvt_pk_bf16_f32 v97, v130, v131
    v_cvt_pk_bf16_f32 v98, v132, v133
    v_cvt_pk_bf16_f32 v99, v134, v135
    v_cvt_pk_bf16_f32 v100, v136, v137
    v_cvt_pk_bf16_f32 v101, v138, v139
    v_cvt_pk_bf16_f32 v102, v140, v141
    v_cvt_pk_bf16_f32 v103, v142, v143
    v_cvt_pk_bf16_f32 v104, v144, v145
    v_cvt_pk_bf16_f32 v105, v146, v147
    v_cvt_pk_bf16_f32 v106, v148, v149
    v_cvt_pk_bf16_f32 v107, v150, v151
    v_cvt_pk_bf16_f32 v108, v152, v153
    v_cvt_pk_bf16_f32 v109, v154, v155
    v_cvt_pk_bf16_f32 v110, v156, v157
    v_cvt_pk_bf16_f32 v111, v158, v159
    v_accvgpr_write_b32 a0, v96
    v_accvgpr_write_b32 a1, v97
    v_accvgpr_write_b32 a2, v98
    v_accvgpr_write_b32 a3, v99
    v_accvgpr_write_b32 a4, v100
    v_accvgpr_write_b32 a5, v101
    v_accvgpr_write_b32 a6, v102
    v_accvgpr_write_b32 a7, v103
    v_accvgpr_write_b32 a8, v104
    v_accvgpr_write_b32 a9, v105
    v_accvgpr_write_b32 a10, v106
    v_accvgpr_write_b32 a11, v107
    v_accvgpr_write_b32 a12, v108
    v_accvgpr_write_b32 a13, v109
    v_accvgpr_write_b32 a14, v110
    v_accvgpr_write_b32 a15, v111
    v_cvt_pk_bf16_f32 v96, v160, v161
    v_cvt_pk_bf16_f32 v97, v162, v163
    v_cvt_pk_bf16_f32 v98, v164, v165
    v_cvt_pk_bf16_f32 v99, v166, v167
    v_cvt_pk_bf16_f32 v100, v168, v169
    v_cvt_pk_bf16_f32 v101, v170, v171
    v_cvt_pk_bf16_f32 v102, v172, v173
    v_cvt_pk_bf16_f32 v103, v174, v175
    v_cvt_pk_bf16_f32 v104, v176, v177
    v_cvt_pk_bf16_f32 v105, v178, v179
    v_cvt_pk_bf16_f32 v106, v180, v181
    v_cvt_pk_bf16_f32 v107, v182, v183
    v_cvt_pk_bf16_f32 v108, v184, v185
    v_cvt_pk_bf16_f32 v109, v186, v187
    v_cvt_pk_bf16_f32 v110, v188, v189
    v_cvt_pk_bf16_f32 v111, v190, v191
    v_accvgpr_write_b32 a16, v96
    v_accvgpr_write_b32 a17, v97
    v_accvgpr_write_b32 a18, v98
    v_accvgpr_write_b32 a19, v99
    v_accvgpr_write_b32 a20, v100
    v_accvgpr_write_b32 a21, v101
    v_accvgpr_write_b32 a22, v102
    v_accvgpr_write_b32 a23, v103
    v_accvgpr_write_b32 a24, v104
    v_accvgpr_write_b32 a25, v105
    v_accvgpr_write_b32 a26, v106
    v_accvgpr_write_b32 a27, v107
    v_accvgpr_write_b32 a28, v108
    v_accvgpr_write_b32 a29, v109
    v_accvgpr_write_b32 a30, v110
    v_accvgpr_write_b32 a31, v111
    v_cvt_pk_bf16_f32 v96, v192, v193
    v_cvt_pk_bf16_f32 v97, v194, v195
    v_cvt_pk_bf16_f32 v98, v196, v197
    v_cvt_pk_bf16_f32 v99, v198, v199
    v_cvt_pk_bf16_f32 v100, v200, v201
    v_cvt_pk_bf16_f32 v101, v202, v203
    v_cvt_pk_bf16_f32 v102, v204, v205
    v_cvt_pk_bf16_f32 v103, v206, v207
    v_cvt_pk_bf16_f32 v104, v208, v209
    v_cvt_pk_bf16_f32 v105, v210, v211
    v_cvt_pk_bf16_f32 v106, v212, v213
    v_cvt_pk_bf16_f32 v107, v214, v215
    v_cvt_pk_bf16_f32 v108, v216, v217
    v_cvt_pk_bf16_f32 v109, v218, v219
    v_cvt_pk_bf16_f32 v110, v220, v221
    v_cvt_pk_bf16_f32 v111, v222, v223
    v_accvgpr_write_b32 a32, v96
    v_accvgpr_write_b32 a33, v97
    v_accvgpr_write_b32 a34, v98
    v_accvgpr_write_b32 a35, v99
    v_accvgpr_write_b32 a36, v100
    v_accvgpr_write_b32 a37, v101
    v_accvgpr_write_b32 a38, v102
    v_accvgpr_write_b32 a39, v103
    v_accvgpr_write_b32 a40, v104
    v_accvgpr_write_b32 a41, v105
    v_accvgpr_write_b32 a42, v106
    v_accvgpr_write_b32 a43, v107
    v_accvgpr_write_b32 a44, v108
    v_accvgpr_write_b32 a45, v109
    v_accvgpr_write_b32 a46, v110
    v_accvgpr_write_b32 a47, v111
    v_cvt_pk_bf16_f32 v96, v224, v225
    v_cvt_pk_bf16_f32 v97, v226, v227
    v_cvt_pk_bf16_f32 v98, v228, v229
    v_cvt_pk_bf16_f32 v99, v230, v231
    v_cvt_pk_bf16_f32 v100, v232, v233
    v_cvt_pk_bf16_f32 v101, v234, v235
    v_cvt_pk_bf16_f32 v102, v236, v237
    v_cvt_pk_bf16_f32 v103, v238, v239
    v_cvt_pk_bf16_f32 v104, v240, v241
    v_cvt_pk_bf16_f32 v105, v242, v243
    v_cvt_pk_bf16_f32 v106, v244, v245
    v_cvt_pk_bf16_f32 v107, v246, v247
    v_cvt_pk_bf16_f32 v108, v248, v249
    v_cvt_pk_bf16_f32 v109, v250, v251
    v_cvt_pk_bf16_f32 v110, v252, v253
    v_cvt_pk_bf16_f32 v111, v254, v255
    v_accvgpr_write_b32 a48, v96
    v_accvgpr_write_b32 a49, v97
    v_accvgpr_write_b32 a50, v98
    v_accvgpr_write_b32 a51, v99
    v_accvgpr_write_b32 a52, v100
    v_accvgpr_write_b32 a53, v101
    v_accvgpr_write_b32 a54, v102
    v_accvgpr_write_b32 a55, v103
    v_accvgpr_write_b32 a56, v104
    v_accvgpr_write_b32 a57, v105
    v_accvgpr_write_b32 a58, v106
    v_accvgpr_write_b32 a59, v107
    v_accvgpr_write_b32 a60, v108
    v_accvgpr_write_b32 a61, v109
    v_accvgpr_write_b32 a62, v110
    v_accvgpr_write_b32 a63, v111
    v_xor_b32 v8, 0, v0
    v_lshlrev_b32 v8, 4, v8
    v_add_u32 v8, 0x1000, v8
    v_xor_b32 v9, 4, v0
    v_lshlrev_b32 v9, 4, v9
    v_add_u32 v9, 0xf80, v9
    v_xor_b32 v10, 8, v0
    v_lshlrev_b32 v10, 4, v10
    v_add_u32 v10, 0xf00, v10
    v_xor_b32 v11, 12, v0
    v_lshlrev_b32 v11, 4, v11
    v_add_u32 v11, 0xe80, v11
    v_xor_b32 v68, 0, v0
    v_lshlrev_b32 v68, 4, v68
    v_add_u32 v68, 0x1e00, v68
    v_xor_b32 v69, 4, v0
    v_lshlrev_b32 v69, 4, v69
    v_add_u32 v69, 0x1d80, v69
    v_xor_b32 v70, 8, v0
    v_lshlrev_b32 v70, 4, v70
    v_add_u32 v70, 0x1d00, v70
    v_xor_b32 v71, 12, v0
    v_lshlrev_b32 v71, 4, v71
    v_add_u32 v71, 0x1c80, v71
    s_mov_b32 s34, 1
    s_add_u32 s62, s33, 0x10000
    s_mov_b32 s64, 0
    s_mov_b32 s68, 0x8000
    s_add_u32 s69, s32, 0x20000
    v_add_u32 v38, s64, v22
    v_add_u32 v39, s64, v23
    v_add_u32 v40, s64, v24
    v_add_u32 v41, s64, v25
    v_add_u32 v42, s64, v26
    v_add_u32 v43, s64, v27
    v_add_u32 v44, s64, v28
    v_add_u32 v45, s64, v29
    s_waitcnt vmcnt(24)
    s_barrier
    ds_read_b128 a[64:67], v38 offset:0
    ds_read_b128 a[68:71], v38 offset:16384
    ds_read_b128 a[72:75], v39 offset:0
    ds_read_b128 a[76:79], v39 offset:16384
    ds_read_b128 a[80:83], v40 offset:0
    ds_read_b128 a[84:87], v40 offset:16384
    ds_read_b128 a[88:91], v41 offset:0
    ds_read_b128 a[92:95], v41 offset:16384
    s_waitcnt lgkmcnt(7)
    v_mfma_f32_32x32x16_bf16 v[96:111], a[64:67], a[0:3], 0
    ds_read_b128 a[96:99], v42 offset:0
    s_add_u32 m0, s69, 0x0
    s_add_u32 s61, s62, 0x0
    buffer_load_dwordx4 v12, s[12:15], s61 offen offset:0 nt lds
    s_waitcnt lgkmcnt(7)
    v_mfma_f32_32x32x16_bf16 v[112:127], a[68:71], a[0:3], 0
    ds_read_b128 a[100:103], v42 offset:16384
    s_waitcnt lgkmcnt(7)
    v_mfma_f32_32x32x16_bf16 v[96:111], a[72:75], a[4:7], v[96:111]
    ds_read_b128 a[104:107], v43 offset:0
    buffer_load_dwordx4 v13, s[12:15], s61 offen offset:1024 nt lds
    s_waitcnt lgkmcnt(7)
    v_mfma_f32_32x32x16_bf16 v[112:127], a[76:79], a[4:7], v[112:127]
    ds_read_b128 a[108:111], v43 offset:16384
    s_waitcnt lgkmcnt(7)
    v_mfma_f32_32x32x16_bf16 v[96:111], a[80:83], a[8:11], v[96:111]
    ds_read_b128 a[112:115], v44 offset:0
    buffer_load_dwordx4 v14, s[12:15], s61 offen offset:2048 nt lds
    s_waitcnt lgkmcnt(7)
    v_mfma_f32_32x32x16_bf16 v[112:127], a[84:87], a[8:11], v[112:127]
    ds_read_b128 a[116:119], v44 offset:16384
    s_waitcnt lgkmcnt(7)
    v_mfma_f32_32x32x16_bf16 v[96:111], a[88:91], a[12:15], v[96:111]
    ds_read_b128 a[120:123], v45 offset:0
    buffer_load_dwordx4 v15, s[12:15], s61 offen offset:3072 nt lds
    s_waitcnt lgkmcnt(7)
    v_mfma_f32_32x32x16_bf16 v[112:127], a[92:95], a[12:15], v[112:127]
    ds_read_b128 a[124:127], v45 offset:16384
    s_waitcnt lgkmcnt(7)
    v_mfma_f32_32x32x16_bf16 v[96:111], a[96:99], a[16:19], v[96:111]
    ds_read_b128 a[64:67], v38 offset:256
    s_add_u32 m0, s69, 0x1000
    s_add_u32 s61, s62, 0x1000
    buffer_load_dwordx4 v16, s[12:15], s61 offen offset:0 nt lds
    s_waitcnt lgkmcnt(7)
    v_mfma_f32_32x32x16_bf16 v[112:127], a[100:103], a[16:19], v[112:127]
    ds_read_b128 a[68:71], v38 offset:16640
    s_waitcnt lgkmcnt(7)
    v_mfma_f32_32x32x16_bf16 v[96:111], a[104:107], a[20:23], v[96:111]
    ds_read_b128 a[72:75], v39 offset:256
    buffer_load_dwordx4 v17, s[12:15], s61 offen offset:1024 nt lds
    s_waitcnt lgkmcnt(7)
    v_mfma_f32_32x32x16_bf16 v[112:127], a[108:111], a[20:23], v[112:127]
    ds_read_b128 a[76:79], v39 offset:16640
    s_waitcnt lgkmcnt(7)
    v_mfma_f32_32x32x16_bf16 v[96:111], a[112:115], a[24:27], v[96:111]
    ds_read_b128 a[80:83], v40 offset:256
    buffer_load_dwordx4 v18, s[12:15], s61 offen offset:2048 nt lds
    s_waitcnt lgkmcnt(7)
    v_mfma_f32_32x32x16_bf16 v[112:127], a[116:119], a[24:27], v[112:127]
    ds_read_b128 a[84:87], v40 offset:16640
    s_waitcnt lgkmcnt(7)
    v_mfma_f32_32x32x16_bf16 v[96:111], a[120:123], a[28:31], v[96:111]
    ds_read_b128 a[88:91], v41 offset:256
    buffer_load_dwordx4 v19, s[12:15], s61 offen offset:3072 nt lds
    s_waitcnt lgkmcnt(7)
    v_mfma_f32_32x32x16_bf16 v[112:127], a[124:127], a[28:31], v[112:127]
    ds_read_b128 a[92:95], v41 offset:16640
    s_waitcnt lgkmcnt(7)
    v_mfma_f32_32x32x16_bf16 v[96:111], a[64:67], a[32:35], v[96:111]
    ds_read_b128 a[96:99], v42 offset:256
    s_waitcnt lgkmcnt(7)
    v_mfma_f32_32x32x16_bf16 v[112:127], a[68:71], a[32:35], v[112:127]
    ds_read_b128 a[100:103], v42 offset:16640
    s_waitcnt lgkmcnt(7)
    v_mfma_f32_32x32x16_bf16 v[96:111], a[72:75], a[36:39], v[96:111]
    ds_read_b128 a[104:107], v43 offset:256
    s_waitcnt lgkmcnt(7)
    v_mfma_f32_32x32x16_bf16 v[112:127], a[76:79], a[36:39], v[112:127]
    ds_read_b128 a[108:111], v43 offset:16640
    s_waitcnt lgkmcnt(7)
    v_mfma_f32_32x32x16_bf16 v[96:111], a[80:83], a[40:43], v[96:111]
    ds_read_b128 a[112:115], v44 offset:256
    s_waitcnt lgkmcnt(7)
    v_mfma_f32_32x32x16_bf16 v[112:127], a[84:87], a[40:43], v[112:127]
    ds_read_b128 a[116:119], v44 offset:16640
    s_waitcnt lgkmcnt(7)
    v_mfma_f32_32x32x16_bf16 v[96:111], a[88:91], a[44:47], v[96:111]
    ds_read_b128 a[120:123], v45 offset:256
    s_waitcnt lgkmcnt(7)
    v_mfma_f32_32x32x16_bf16 v[112:127], a[92:95], a[44:47], v[112:127]
    ds_read_b128 a[124:127], v45 offset:16640
    s_waitcnt lgkmcnt(7)
    v_mfma_f32_32x32x16_bf16 v[96:111], a[96:99], a[48:51], v[96:111]
    s_waitcnt lgkmcnt(6)
    v_mfma_f32_32x32x16_bf16 v[112:127], a[100:103], a[48:51], v[112:127]
    s_waitcnt lgkmcnt(5)
    v_mfma_f32_32x32x16_bf16 v[96:111], a[104:107], a[52:55], v[96:111]
    s_waitcnt lgkmcnt(4)
    v_mfma_f32_32x32x16_bf16 v[112:127], a[108:111], a[52:55], v[112:127]
    s_waitcnt lgkmcnt(3)
    v_mfma_f32_32x32x16_bf16 v[96:111], a[112:115], a[56:59], v[96:111]
    s_waitcnt lgkmcnt(2)
    v_mfma_f32_32x32x16_bf16 v[112:127], a[116:119], a[56:59], v[112:127]
    s_waitcnt lgkmcnt(1)
    v_mfma_f32_32x32x16_bf16 v[96:111], a[120:123], a[60:63], v[96:111]
    s_waitcnt lgkmcnt(0)
    v_mfma_f32_32x32x16_bf16 v[112:127], a[124:127], a[60:63], v[112:127]
    s_nop 15
    v_max3_f32 v60, v96, v97, v98
    v_max3_f32 v61, v99, v100, v101
    v_max3_f32 v60, v60, v102, v103
    v_max3_f32 v61, v61, v104, v105
    v_max3_f32 v60, v60, v106, v107
    v_max3_f32 v61, v61, v108, v109
    v_max3_f32 v60, v60, v110, v111
    v_max3_f32 v61, v61, v112, v113
    v_max3_f32 v60, v60, v114, v115
    v_max3_f32 v61, v61, v116, v117
    v_max3_f32 v60, v60, v118, v119
    v_max3_f32 v61, v61, v120, v121
    v_max3_f32 v60, v60, v122, v123
    v_max3_f32 v61, v61, v124, v125
    v_max3_f32 v60, v60, v126, v127
    v_max_f32 v60, v60, v61
    v_mov_b32 v61, v60
    s_nop 1
    v_permlane32_swap_b32 v60, v61
    v_max_f32 v60, v60, v61
    v_mov_b32 v56, v60
    v_mul_f32 v59, s35, v60
    v_sub_f32 v59, 0, v59
    v_fma_f32 v96, v96, s35, v59
    v_fma_f32 v97, v97, s35, v59
    v_fma_f32 v98, v98, s35, v59
    v_fma_f32 v99, v99, s35, v59
    v_fma_f32 v100, v100, s35, v59
    v_fma_f32 v101, v101, s35, v59
    v_fma_f32 v102, v102, s35, v59
    v_fma_f32 v103, v103, s35, v59
    v_fma_f32 v104, v104, s35, v59
    v_fma_f32 v105, v105, s35, v59
    v_fma_f32 v106, v106, s35, v59
    v_fma_f32 v107, v107, s35, v59
    v_fma_f32 v108, v108, s35, v59
    v_fma_f32 v109, v109, s35, v59
    v_fma_f32 v110, v110, s35, v59
    v_fma_f32 v111, v111, s35, v59
    v_fma_f32 v112, v112, s35, v59
    v_fma_f32 v113, v113, s35, v59
    v_fma_f32 v114, v114, s35, v59
    v_fma_f32 v115, v115, s35, v59
    v_fma_f32 v116, v116, s35, v59
    v_fma_f32 v117, v117, s35, v59
    v_fma_f32 v118, v118, s35, v59
    v_fma_f32 v119, v119, s35, v59
    v_fma_f32 v120, v120, s35, v59
    v_fma_f32 v121, v121, s35, v59
    v_fma_f32 v122, v122, s35, v59
    v_fma_f32 v123, v123, s35, v59
    v_fma_f32 v124, v124, s35, v59
    v_fma_f32 v125, v125, s35, v59
    v_fma_f32 v126, v126, s35, v59
    v_fma_f32 v127, v127, s35, v59
    v_exp_f32 v96, v96
    v_exp_f32 v97, v97
    v_exp_f32 v98, v98
    v_exp_f32 v99, v99
    v_exp_f32 v100, v100
    v_exp_f32 v101, v101
    v_exp_f32 v102, v102
    v_exp_f32 v103, v103
    v_exp_f32 v104, v104
    v_exp_f32 v105, v105
    v_exp_f32 v106, v106
    v_exp_f32 v107, v107
    v_exp_f32 v108, v108
    v_exp_f32 v109, v109
    v_exp_f32 v110, v110
    v_exp_f32 v111, v111
    v_exp_f32 v112, v112
    v_exp_f32 v113, v113
    v_exp_f32 v114, v114
    v_exp_f32 v115, v115
    v_exp_f32 v116, v116
    v_exp_f32 v117, v117
    v_exp_f32 v118, v118
    v_exp_f32 v119, v119
    v_exp_f32 v120, v120
    v_exp_f32 v121, v121
    v_exp_f32 v122, v122
    v_exp_f32 v123, v123
    v_exp_f32 v124, v124
    v_exp_f32 v125, v125
    v_exp_f32 v126, v126
    v_exp_f32 v127, v127
    s_nop 0
    v_add_f32 v64, v96, v100
    v_add_f32 v65, v97, v101
    v_add_f32 v66, v98, v102
    v_add_f32 v67, v99, v103
    v_add_f32 v64, v64, v104
    v_add_f32 v65, v65, v105
    v_add_f32 v66, v66, v106
    v_add_f32 v67, v67, v107
    v_add_f32 v64, v64, v108
    v_add_f32 v65, v65, v109
    v_add_f32 v66, v66, v110
    v_add_f32 v67, v67, v111
    v_add_f32 v64, v64, v112
    v_add_f32 v65, v65, v113
    v_add_f32 v66, v66, v114
    v_add_f32 v67, v67, v115
    v_add_f32 v64, v64, v116
    v_add_f32 v65, v65, v117
    v_add_f32 v66, v66, v118
    v_add_f32 v67, v67, v119
    v_add_f32 v64, v64, v120
    v_add_f32 v65, v65, v121
    v_add_f32 v66, v66, v122
    v_add_f32 v67, v67, v123
    v_add_f32 v64, v64, v124
    v_add_f32 v65, v65, v125
    v_add_f32 v66, v66, v126
    v_add_f32 v67, v67, v127
    v_add_f32 v64, v64, v65
    v_add_f32 v66, v66, v67
    v_add_f32 v64, v64, v66
    v_mov_b32 v57, v64
    v_cvt_pk_bf16_f32 v80, v96, v97
    v_cvt_pk_bf16_f32 v81, v98, v99
    v_cvt_pk_bf16_f32 v82, v100, v101
    v_cvt_pk_bf16_f32 v83, v102, v103
    v_cvt_pk_bf16_f32 v84, v104, v105
    v_cvt_pk_bf16_f32 v85, v106, v107
    v_cvt_pk_bf16_f32 v86, v108, v109
    v_cvt_pk_bf16_f32 v87, v110, v111
    v_cvt_pk_bf16_f32 v88, v112, v113
    v_cvt_pk_bf16_f32 v89, v114, v115
    v_cvt_pk_bf16_f32 v90, v116, v117
    v_cvt_pk_bf16_f32 v91, v118, v119
    v_cvt_pk_bf16_f32 v92, v120, v121
    v_cvt_pk_bf16_f32 v93, v122, v123
    v_cvt_pk_bf16_f32 v94, v124, v125
    v_cvt_pk_bf16_f32 v95, v126, v127
    v_add_u32 v38, s68, v30
    v_add_u32 v39, s68, v31
    v_add_u32 v40, s68, v32
    v_add_u32 v41, s68, v33
    s_add_u32 s63, s64, s32
    s_waitcnt vmcnt(24)
    s_barrier
    ds_read_b64_tr_b16 a[64:65], v38 offset:0
    ds_read_b64_tr_b16 a[66:67], v38 offset:4096
    ds_read_b64_tr_b16 a[68:69], v39 offset:0
    ds_read_b64_tr_b16 a[70:71], v39 offset:4096
    ds_read_b64_tr_b16 a[72:73], v40 offset:0
    ds_read_b64_tr_b16 a[74:75], v40 offset:4096
    ds_read_b64_tr_b16 a[76:77], v41 offset:0
    ds_read_b64_tr_b16 a[78:79], v41 offset:4096
    ds_read_b64_tr_b16 a[80:81], v38 offset:256
    ds_read_b64_tr_b16 a[82:83], v38 offset:4352
    ds_read_b64_tr_b16 a[84:85], v39 offset:256
    ds_read_b64_tr_b16 a[86:87], v39 offset:4352
    s_waitcnt lgkmcnt(10)
    v_mfma_f32_32x32x16_bf16 v[128:143], a[64:67], v[80:83], 0
    ds_read_b64_tr_b16 a[88:89], v40 offset:256
    ds_read_b64_tr_b16 a[90:91], v40 offset:4352
    s_add_u32 m0, s63, 0x0
    s_add_u32 s61, s62, 0x0
    buffer_load_dwordx4 v20, s[16:19], s61 offen offset:0 nt lds
    s_waitcnt lgkmcnt(10)
    v_mfma_f32_32x32x16_bf16 v[144:159], a[68:71], v[80:83], 0
    ds_read_b64_tr_b16 a[92:93], v41 offset:256
    ds_read_b64_tr_b16 a[94:95], v41 offset:4352
    s_waitcnt lgkmcnt(10)
    v_mfma_f32_32x32x16_bf16 v[160:175], a[72:75], v[80:83], 0
    ds_read_b64_tr_b16 a[96:97], v38 offset:8192
    ds_read_b64_tr_b16 a[98:99], v38 offset:12288
    buffer_load_dwordx4 v21, s[16:19], s61 offen offset:1024 nt lds
    s_waitcnt lgkmcnt(10)
    v_mfma_f32_32x32x16_bf16 v[176:191], a[76:79], v[80:83], 0
    ds_read_b64_tr_b16 a[100:101], v39 offset:8192
    ds_read_b64_tr_b16 a[102:103], v39 offset:12288
    s_waitcnt lgkmcnt(10)
    v_mfma_f32_32x32x16_bf16 v[192:207], a[80:83], v[80:83], 0
    ds_read_b64_tr_b16 a[104:105], v40 offset:8192
    ds_read_b64_tr_b16 a[106:107], v40 offset:12288
    buffer_load_dwordx4 v20, s[16:19], s61 offen offset:2048 nt lds
    s_waitcnt lgkmcnt(10)
    v_mfma_f32_32x32x16_bf16 v[208:223], a[84:87], v[80:83], 0
    ds_read_b64_tr_b16 a[108:109], v41 offset:8192
    ds_read_b64_tr_b16 a[110:111], v41 offset:12288
    s_waitcnt lgkmcnt(10)
    v_mfma_f32_32x32x16_bf16 v[224:239], a[88:91], v[80:83], 0
    ds_read_b64_tr_b16 a[112:113], v38 offset:8448
    ds_read_b64_tr_b16 a[114:115], v38 offset:12544
    buffer_load_dwordx4 v21, s[16:19], s61 offen offset:3072 nt lds
    s_waitcnt lgkmcnt(10)
    v_mfma_f32_32x32x16_bf16 v[240:255], a[92:95], v[80:83], 0
    ds_read_b64_tr_b16 a[116:117], v39 offset:8448
    ds_read_b64_tr_b16 a[118:119], v39 offset:12544
    s_waitcnt lgkmcnt(10)
    v_mfma_f32_32x32x16_bf16 v[128:143], a[96:99], v[84:87], v[128:143]
    ds_read_b64_tr_b16 a[120:121], v40 offset:8448
    ds_read_b64_tr_b16 a[122:123], v40 offset:12544
    s_add_u32 m0, s63, 0x1000
    s_add_u32 s61, s62, 0x1000
    buffer_load_dwordx4 v20, s[16:19], s61 offen offset:0 nt lds
    s_waitcnt lgkmcnt(10)
    v_mfma_f32_32x32x16_bf16 v[144:159], a[100:103], v[84:87], v[144:159]
    ds_read_b64_tr_b16 a[124:125], v41 offset:8448
    ds_read_b64_tr_b16 a[126:127], v41 offset:12544
    s_waitcnt lgkmcnt(10)
    v_mfma_f32_32x32x16_bf16 v[160:175], a[104:107], v[84:87], v[160:175]
    ds_read_b64_tr_b16 a[64:65], v38 offset:16384
    ds_read_b64_tr_b16 a[66:67], v38 offset:20480
    buffer_load_dwordx4 v21, s[16:19], s61 offen offset:1024 nt lds
    s_waitcnt lgkmcnt(10)
    v_mfma_f32_32x32x16_bf16 v[176:191], a[108:111], v[84:87], v[176:191]
    ds_read_b64_tr_b16 a[68:69], v39 offset:16384
    ds_read_b64_tr_b16 a[70:71], v39 offset:20480
    s_waitcnt lgkmcnt(10)
    v_mfma_f32_32x32x16_bf16 v[192:207], a[112:115], v[84:87], v[192:207]
    ds_read_b64_tr_b16 a[72:73], v40 offset:16384
    ds_read_b64_tr_b16 a[74:75], v40 offset:20480
    buffer_load_dwordx4 v20, s[16:19], s61 offen offset:2048 nt lds
    s_waitcnt lgkmcnt(10)
    v_mfma_f32_32x32x16_bf16 v[208:223], a[116:119], v[84:87], v[208:223]
    ds_read_b64_tr_b16 a[76:77], v41 offset:16384
    ds_read_b64_tr_b16 a[78:79], v41 offset:20480
    s_waitcnt lgkmcnt(10)
    v_mfma_f32_32x32x16_bf16 v[224:239], a[120:123], v[84:87], v[224:239]
    ds_read_b64_tr_b16 a[80:81], v38 offset:16640
    ds_read_b64_tr_b16 a[82:83], v38 offset:20736
    buffer_load_dwordx4 v21, s[16:19], s61 offen offset:3072 nt lds
    s_waitcnt lgkmcnt(10)
    v_mfma_f32_32x32x16_bf16 v[240:255], a[124:127], v[84:87], v[240:255]
    ds_read_b64_tr_b16 a[84:85], v39 offset:16640
    ds_read_b64_tr_b16 a[86:87], v39 offset:20736
    s_waitcnt lgkmcnt(10)
    v_mfma_f32_32x32x16_bf16 v[128:143], a[64:67], v[88:91], v[128:143]
    ds_read_b64_tr_b16 a[88:89], v40 offset:16640
    ds_read_b64_tr_b16 a[90:91], v40 offset:20736
    s_waitcnt lgkmcnt(10)
    v_mfma_f32_32x32x16_bf16 v[144:159], a[68:71], v[88:91], v[144:159]
    ds_read_b64_tr_b16 a[92:93], v41 offset:16640
    ds_read_b64_tr_b16 a[94:95], v41 offset:20736
    s_waitcnt lgkmcnt(10)
    v_mfma_f32_32x32x16_bf16 v[160:175], a[72:75], v[88:91], v[160:175]
    ds_read_b64_tr_b16 a[96:97], v38 offset:24576
    ds_read_b64_tr_b16 a[98:99], v38 offset:28672
    s_waitcnt lgkmcnt(10)
    v_mfma_f32_32x32x16_bf16 v[176:191], a[76:79], v[88:91], v[176:191]
    ds_read_b64_tr_b16 a[100:101], v39 offset:24576
    ds_read_b64_tr_b16 a[102:103], v39 offset:28672
    s_waitcnt lgkmcnt(10)
    v_mfma_f32_32x32x16_bf16 v[192:207], a[80:83], v[88:91], v[192:207]
    ds_read_b64_tr_b16 a[104:105], v40 offset:24576
    ds_read_b64_tr_b16 a[106:107], v40 offset:28672
    s_waitcnt lgkmcnt(10)
    v_mfma_f32_32x32x16_bf16 v[208:223], a[84:87], v[88:91], v[208:223]
    ds_read_b64_tr_b16 a[108:109], v41 offset:24576
    ds_read_b64_tr_b16 a[110:111], v41 offset:28672
    s_waitcnt lgkmcnt(10)
    v_mfma_f32_32x32x16_bf16 v[224:239], a[88:91], v[88:91], v[224:239]
    ds_read_b64_tr_b16 a[112:113], v38 offset:24832
    ds_read_b64_tr_b16 a[114:115], v38 offset:28928
    s_waitcnt lgkmcnt(10)
    v_mfma_f32_32x32x16_bf16 v[240:255], a[92:95], v[88:91], v[240:255]
    ds_read_b64_tr_b16 a[116:117], v39 offset:24832
    ds_read_b64_tr_b16 a[118:119], v39 offset:28928
    s_waitcnt lgkmcnt(10)
    v_mfma_f32_32x32x16_bf16 v[128:143], a[96:99], v[92:95], v[128:143]
    ds_read_b64_tr_b16 a[120:121], v40 offset:24832
    ds_read_b64_tr_b16 a[122:123], v40 offset:28928
    s_waitcnt lgkmcnt(10)
    v_mfma_f32_32x32x16_bf16 v[144:159], a[100:103], v[92:95], v[144:159]
    ds_read_b64_tr_b16 a[124:125], v41 offset:24832
    ds_read_b64_tr_b16 a[126:127], v41 offset:28928
    s_waitcnt lgkmcnt(10)
    v_mfma_f32_32x32x16_bf16 v[160:175], a[104:107], v[92:95], v[160:175]
    s_waitcnt lgkmcnt(8)
    v_mfma_f32_32x32x16_bf16 v[176:191], a[108:111], v[92:95], v[176:191]
    s_waitcnt lgkmcnt(6)
    v_mfma_f32_32x32x16_bf16 v[192:207], a[112:115], v[92:95], v[192:207]
    s_waitcnt lgkmcnt(4)
    v_mfma_f32_32x32x16_bf16 v[208:223], a[116:119], v[92:95], v[208:223]
    s_waitcnt lgkmcnt(2)
    v_mfma_f32_32x32x16_bf16 v[224:239], a[120:123], v[92:95], v[224:239]
    s_waitcnt lgkmcnt(0)
    v_mfma_f32_32x32x16_bf16 v[240:255], a[124:127], v[92:95], v[240:255]
    s_add_u32 s64, s64, 0x10000
    s_cmp_ge_u32 s64, 0x28000
    s_cselect_b32 s60, 0x28000, 0
    s_sub_u32 s64, s64, s60
    s_add_u32 s68, s68, 0x10000
    s_cmp_ge_u32 s68, 0x28000
    s_cselect_b32 s60, 0x28000, 0
    s_sub_u32 s68, s68, s60
    s_add_u32 s69, s69, 0x10000
    s_cmp_ge_u32 s69, 0x28000
    s_cselect_b32 s60, 0x28000, 0
    s_sub_u32 s69, s69, s60
    s_add_u32 s62, s62, 0x8000
L_loop:
    v_add_u32 v38, s64, v22
    v_add_u32 v39, s64, v23
    v_add_u32 v40, s64, v24
    v_add_u32 v41, s64, v25
    v_add_u32 v42, s64, v26
    v_add_u32 v43, s64, v27
    v_add_u32 v44, s64, v28
    v_add_u32 v45, s64, v29
    s_waitcnt vmcnt(24)
    s_barrier
    ds_read_b128 a[64:67], v38 offset:0
    ds_read_b128 a[68:71], v38 offset:16384
    ds_read_b128 a[72:75], v39 offset:0
    ds_read_b128 a[76:79], v39 offset:16384
    ds_read_b128 a[80:83], v40 offset:0
    ds_read_b128 a[84:87], v40 offset:16384
    ds_read_b128 a[88:91], v41 offset:0
    ds_read_b128 a[92:95], v41 offset:16384
    s_waitcnt lgkmcnt(7)
    v_mfma_f32_32x32x16_bf16 v[96:111], a[64:67], a[0:3], 0
    ds_read_b128 a[96:99], v42 offset:0
    s_add_u32 m0, s69, 0x0
    s_add_u32 s61, s62, 0x0
    buffer_load_dwordx4 v12, s[12:15], s61 offen offset:0 nt lds
    s_waitcnt lgkmcnt(7)
    v_mfma_f32_32x32x16_bf16 v[112:127], a[68:71], a[0:3], 0
    ds_read_b128 a[100:103], v42 offset:16384
    s_waitcnt lgkmcnt(7)
    v_mfma_f32_32x32x16_bf16 v[96:111], a[72:75], a[4:7], v[96:111]
    ds_read_b128 a[104:107], v43 offset:0
    buffer_load_dwordx4 v13, s[12:15], s61 offen offset:1024 nt lds
    s_waitcnt lgkmcnt(7)
    v_mfma_f32_32x32x16_bf16 v[112:127], a[76:79], a[4:7], v[112:127]
    ds_read_b128 a[108:111], v43 offset:16384
    s_waitcnt lgkmcnt(7)
    v_mfma_f32_32x32x16_bf16 v[96:111], a[80:83], a[8:11], v[96:111]
    ds_read_b128 a[112:115], v44 offset:0
    buffer_load_dwordx4 v14, s[12:15], s61 offen offset:2048 nt lds
    s_waitcnt lgkmcnt(7)
    v_mfma_f32_32x32x16_bf16 v[112:127], a[84:87], a[8:11], v[112:127]
    ds_read_b128 a[116:119], v44 offset:16384
    s_waitcnt lgkmcnt(7)
    v_mfma_f32_32x32x16_bf16 v[96:111], a[88:91], a[12:15], v[96:111]
    ds_read_b128 a[120:123], v45 offset:0
    buffer_load_dwordx4 v15, s[12:15], s61 offen offset:3072 nt lds
    s_waitcnt lgkmcnt(7)
    v_mfma_f32_32x32x16_bf16 v[112:127], a[92:95], a[12:15], v[112:127]
    ds_read_b128 a[124:127], v45 offset:16384
    s_waitcnt lgkmcnt(7)
    v_mfma_f32_32x32x16_bf16 v[96:111], a[96:99], a[16:19], v[96:111]
    ds_read_b128 a[64:67], v38 offset:256
    s_add_u32 m0, s69, 0x1000
    s_add_u32 s61, s62, 0x1000
    buffer_load_dwordx4 v16, s[12:15], s61 offen offset:0 nt lds
    s_waitcnt lgkmcnt(7)
    v_mfma_f32_32x32x16_bf16 v[112:127], a[100:103], a[16:19], v[112:127]
    ds_read_b128 a[68:71], v38 offset:16640
    s_waitcnt lgkmcnt(7)
    v_mfma_f32_32x32x16_bf16 v[96:111], a[104:107], a[20:23], v[96:111]
    ds_read_b128 a[72:75], v39 offset:256
    buffer_load_dwordx4 v17, s[12:15], s61 offen offset:1024 nt lds
    s_waitcnt lgkmcnt(7)
    v_mfma_f32_32x32x16_bf16 v[112:127], a[108:111], a[20:23], v[112:127]
    ds_read_b128 a[76:79], v39 offset:16640
    s_waitcnt lgkmcnt(7)
    v_mfma_f32_32x32x16_bf16 v[96:111], a[112:115], a[24:27], v[96:111]
    ds_read_b128 a[80:83], v40 offset:256
    buffer_load_dwordx4 v18, s[12:15], s61 offen offset:2048 nt lds
    s_waitcnt lgkmcnt(7)
    v_mfma_f32_32x32x16_bf16 v[112:127], a[116:119], a[24:27], v[112:127]
    ds_read_b128 a[84:87], v40 offset:16640
    s_waitcnt lgkmcnt(7)
    v_mfma_f32_32x32x16_bf16 v[96:111], a[120:123], a[28:31], v[96:111]
    ds_read_b128 a[88:91], v41 offset:256
    buffer_load_dwordx4 v19, s[12:15], s61 offen offset:3072 nt lds
    s_waitcnt lgkmcnt(7)
    v_mfma_f32_32x32x16_bf16 v[112:127], a[124:127], a[28:31], v[112:127]
    ds_read_b128 a[92:95], v41 offset:16640
    s_waitcnt lgkmcnt(7)
    v_mfma_f32_32x32x16_bf16 v[96:111], a[64:67], a[32:35], v[96:111]
    ds_read_b128 a[96:99], v42 offset:256
    s_waitcnt lgkmcnt(7)
    v_mfma_f32_32x32x16_bf16 v[112:127], a[68:71], a[32:35], v[112:127]
    ds_read_b128 a[100:103], v42 offset:16640
    s_waitcnt lgkmcnt(7)
    v_mfma_f32_32x32x16_bf16 v[96:111], a[72:75], a[36:39], v[96:111]
    ds_read_b128 a[104:107], v43 offset:256
    s_waitcnt lgkmcnt(7)
    v_mfma_f32_32x32x16_bf16 v[112:127], a[76:79], a[36:39], v[112:127]
    ds_read_b128 a[108:111], v43 offset:16640
    s_waitcnt lgkmcnt(7)
    v_mfma_f32_32x32x16_bf16 v[96:111], a[80:83], a[40:43], v[96:111]
    ds_read_b128 a[112:115], v44 offset:256
    s_waitcnt lgkmcnt(7)
    v_mfma_f32_32x32x16_bf16 v[112:127], a[84:87], a[40:43], v[112:127]
    ds_read_b128 a[116:119], v44 offset:16640
    s_waitcnt lgkmcnt(7)
    v_mfma_f32_32x32x16_bf16 v[96:111], a[88:91], a[44:47], v[96:111]
    ds_read_b128 a[120:123], v45 offset:256
    s_waitcnt lgkmcnt(7)
    v_mfma_f32_32x32x16_bf16 v[112:127], a[92:95], a[44:47], v[112:127]
    ds_read_b128 a[124:127], v45 offset:16640
    s_waitcnt lgkmcnt(7)
    v_mfma_f32_32x32x16_bf16 v[96:111], a[96:99], a[48:51], v[96:111]
    s_waitcnt lgkmcnt(6)
    v_mfma_f32_32x32x16_bf16 v[112:127], a[100:103], a[48:51], v[112:127]
    s_waitcnt lgkmcnt(5)
    v_mfma_f32_32x32x16_bf16 v[96:111], a[104:107], a[52:55], v[96:111]
    s_waitcnt lgkmcnt(4)
    v_mfma_f32_32x32x16_bf16 v[112:127], a[108:111], a[52:55], v[112:127]
    s_waitcnt lgkmcnt(3)
    v_mfma_f32_32x32x16_bf16 v[96:111], a[112:115], a[56:59], v[96:111]
    s_waitcnt lgkmcnt(2)
    v_mfma_f32_32x32x16_bf16 v[112:127], a[116:119], a[56:59], v[112:127]
    s_waitcnt lgkmcnt(1)
    v_mfma_f32_32x32x16_bf16 v[96:111], a[120:123], a[60:63], v[96:111]
    s_waitcnt lgkmcnt(0)
    v_mfma_f32_32x32x16_bf16 v[112:127], a[124:127], a[60:63], v[112:127]
    s_nop 15
    v_max3_f32 v60, v96, v97, v98
    v_max3_f32 v61, v99, v100, v101
    v_max3_f32 v60, v60, v102, v103
    v_max3_f32 v61, v61, v104, v105
    v_max3_f32 v60, v60, v106, v107
    v_max3_f32 v61, v61, v108, v109
    v_max3_f32 v60, v60, v110, v111
    v_max3_f32 v61, v61, v112, v113
    v_max3_f32 v60, v60, v114, v115
    v_max3_f32 v61, v61, v116, v117
    v_max3_f32 v60, v60, v118, v119
    v_max3_f32 v61, v61, v120, v121
    v_max3_f32 v60, v60, v122, v123
    v_max3_f32 v61, v61, v124, v125
    v_max3_f32 v60, v60, v126, v127
    v_max_f32 v60, v60, v61
    v_mov_b32 v61, v60
    s_nop 1
    v_permlane32_swap_b32 v60, v61
    v_max3_f32 v60, v60, v61, v56
    v_sub_f32 v58, v56, v60
    v_mul_f32 v58, s35, v58
    v_exp_f32 v58, v58
    v_mov_b32 v56, v60
    v_mul_f32 v59, s35, v60
    v_sub_f32 v59, 0, v59
    v_fma_f32 v96, v96, s35, v59
    v_fma_f32 v97, v97, s35, v59
    v_fma_f32 v98, v98, s35, v59
    v_fma_f32 v99, v99, s35, v59
    v_fma_f32 v100, v100, s35, v59
    v_fma_f32 v101, v101, s35, v59
    v_fma_f32 v102, v102, s35, v59
    v_fma_f32 v103, v103, s35, v59
    v_fma_f32 v104, v104, s35, v59
    v_fma_f32 v105, v105, s35, v59
    v_fma_f32 v106, v106, s35, v59
    v_fma_f32 v107, v107, s35, v59
    v_fma_f32 v108, v108, s35, v59
    v_fma_f32 v109, v109, s35, v59
    v_fma_f32 v110, v110, s35, v59
    v_fma_f32 v111, v111, s35, v59
    v_fma_f32 v112, v112, s35, v59
    v_fma_f32 v113, v113, s35, v59
    v_fma_f32 v114, v114, s35, v59
    v_fma_f32 v115, v115, s35, v59
    v_fma_f32 v116, v116, s35, v59
    v_fma_f32 v117, v117, s35, v59
    v_fma_f32 v118, v118, s35, v59
    v_fma_f32 v119, v119, s35, v59
    v_fma_f32 v120, v120, s35, v59
    v_fma_f32 v121, v121, s35, v59
    v_fma_f32 v122, v122, s35, v59
    v_fma_f32 v123, v123, s35, v59
    v_fma_f32 v124, v124, s35, v59
    v_fma_f32 v125, v125, s35, v59
    v_fma_f32 v126, v126, s35, v59
    v_fma_f32 v127, v127, s35, v59
    v_exp_f32 v96, v96
    v_exp_f32 v97, v97
    v_exp_f32 v98, v98
    v_exp_f32 v99, v99
    v_exp_f32 v100, v100
    v_exp_f32 v101, v101
    v_exp_f32 v102, v102
    v_exp_f32 v103, v103
    v_exp_f32 v104, v104
    v_exp_f32 v105, v105
    v_exp_f32 v106, v106
    v_exp_f32 v107, v107
    v_exp_f32 v108, v108
    v_exp_f32 v109, v109
    v_exp_f32 v110, v110
    v_exp_f32 v111, v111
    v_exp_f32 v112, v112
    v_exp_f32 v113, v113
    v_exp_f32 v114, v114
    v_exp_f32 v115, v115
    v_exp_f32 v116, v116
    v_exp_f32 v117, v117
    v_exp_f32 v118, v118
    v_exp_f32 v119, v119
    v_exp_f32 v120, v120
    v_exp_f32 v121, v121
    v_exp_f32 v122, v122
    v_exp_f32 v123, v123
    v_exp_f32 v124, v124
    v_exp_f32 v125, v125
    v_exp_f32 v126, v126
    v_exp_f32 v127, v127
    v_mul_f32 v57, v57, v58
    v_add_f32 v64, v96, v100
    v_add_f32 v65, v97, v101
    v_add_f32 v66, v98, v102
    v_add_f32 v67, v99, v103
    v_add_f32 v64, v64, v104
    v_add_f32 v65, v65, v105
    v_add_f32 v66, v66, v106
    v_add_f32 v67, v67, v107
    v_add_f32 v64, v64, v108
    v_add_f32 v65, v65, v109
    v_add_f32 v66, v66, v110
    v_add_f32 v67, v67, v111
    v_add_f32 v64, v64, v112
    v_add_f32 v65, v65, v113
    v_add_f32 v66, v66, v114
    v_add_f32 v67, v67, v115
    v_add_f32 v64, v64, v116
    v_add_f32 v65, v65, v117
    v_add_f32 v66, v66, v118
    v_add_f32 v67, v67, v119
    v_add_f32 v64, v64, v120
    v_add_f32 v65, v65, v121
    v_add_f32 v66, v66, v122
    v_add_f32 v67, v67, v123
    v_add_f32 v64, v64, v124
    v_add_f32 v65, v65, v125
    v_add_f32 v66, v66, v126
    v_add_f32 v67, v67, v127
    v_add_f32 v64, v64, v65
    v_add_f32 v66, v66, v67
    v_add_f32 v64, v64, v66
    v_add_f32 v57, v57, v64
    v_cvt_pk_bf16_f32 v80, v96, v97
    v_cvt_pk_bf16_f32 v81, v98, v99
    v_cvt_pk_bf16_f32 v82, v100, v101
    v_cvt_pk_bf16_f32 v83, v102, v103
    v_cvt_pk_bf16_f32 v84, v104, v105
    v_cvt_pk_bf16_f32 v85, v106, v107
    v_cvt_pk_bf16_f32 v86, v108, v109
    v_cvt_pk_bf16_f32 v87, v110, v111
    v_cvt_pk_bf16_f32 v88, v112, v113
    v_cvt_pk_bf16_f32 v89, v114, v115
    v_cvt_pk_bf16_f32 v90, v116, v117
    v_cvt_pk_bf16_f32 v91, v118, v119
    v_cvt_pk_bf16_f32 v92, v120, v121
    v_cvt_pk_bf16_f32 v93, v122, v123
    v_cvt_pk_bf16_f32 v94, v124, v125
    v_cvt_pk_bf16_f32 v95, v126, v127
    v_mul_f32 v128, v58, v128
    v_mul_f32 v129, v58, v129
    v_mul_f32 v130, v58, v130
    v_mul_f32 v131, v58, v131
    v_mul_f32 v132, v58, v132
    v_mul_f32 v133, v58, v133
    v_mul_f32 v134, v58, v134
    v_mul_f32 v135, v58, v135
    v_mul_f32 v136, v58, v136
    v_mul_f32 v137, v58, v137
    v_mul_f32 v138, v58, v138
    v_mul_f32 v139, v58, v139
    v_mul_f32 v140, v58, v140
    v_mul_f32 v141, v58, v141
    v_mul_f32 v142, v58, v142
    v_mul_f32 v143, v58, v143
    v_mul_f32 v144, v58, v144
    v_mul_f32 v145, v58, v145
    v_mul_f32 v146, v58, v146
    v_mul_f32 v147, v58, v147
    v_mul_f32 v148, v58, v148
    v_mul_f32 v149, v58, v149
    v_mul_f32 v150, v58, v150
    v_mul_f32 v151, v58, v151
    v_mul_f32 v152, v58, v152
    v_mul_f32 v153, v58, v153
    v_mul_f32 v154, v58, v154
    v_mul_f32 v155, v58, v155
    v_mul_f32 v156, v58, v156
    v_mul_f32 v157, v58, v157
    v_mul_f32 v158, v58, v158
    v_mul_f32 v159, v58, v159
    v_mul_f32 v160, v58, v160
    v_mul_f32 v161, v58, v161
    v_mul_f32 v162, v58, v162
    v_mul_f32 v163, v58, v163
    v_mul_f32 v164, v58, v164
    v_mul_f32 v165, v58, v165
    v_mul_f32 v166, v58, v166
    v_mul_f32 v167, v58, v167
    v_mul_f32 v168, v58, v168
    v_mul_f32 v169, v58, v169
    v_mul_f32 v170, v58, v170
    v_mul_f32 v171, v58, v171
    v_mul_f32 v172, v58, v172
    v_mul_f32 v173, v58, v173
    v_mul_f32 v174, v58, v174
    v_mul_f32 v175, v58, v175
    v_mul_f32 v176, v58, v176
    v_mul_f32 v177, v58, v177
    v_mul_f32 v178, v58, v178
    v_mul_f32 v179, v58, v179
    v_mul_f32 v180, v58, v180
    v_mul_f32 v181, v58, v181
    v_mul_f32 v182, v58, v182
    v_mul_f32 v183, v58, v183
    v_mul_f32 v184, v58, v184
    v_mul_f32 v185, v58, v185
    v_mul_f32 v186, v58, v186
    v_mul_f32 v187, v58, v187
    v_mul_f32 v188, v58, v188
    v_mul_f32 v189, v58, v189
    v_mul_f32 v190, v58, v190
    v_mul_f32 v191, v58, v191
    v_mul_f32 v192, v58, v192
    v_mul_f32 v193, v58, v193
    v_mul_f32 v194, v58, v194
    v_mul_f32 v195, v58, v195
    v_mul_f32 v196, v58, v196
    v_mul_f32 v197, v58, v197
    v_mul_f32 v198, v58, v198
    v_mul_f32 v199, v58, v199
    v_mul_f32 v200, v58, v200
    v_mul_f32 v201, v58, v201
    v_mul_f32 v202, v58, v202
    v_mul_f32 v203, v58, v203
    v_mul_f32 v204, v58, v204
    v_mul_f32 v205, v58, v205
    v_mul_f32 v206, v58, v206
    v_mul_f32 v207, v58, v207
    v_mul_f32 v208, v58, v208
    v_mul_f32 v209, v58, v209
    v_mul_f32 v210, v58, v210
    v_mul_f32 v211, v58, v211
    v_mul_f32 v212, v58, v212
    v_mul_f32 v213, v58, v213
    v_mul_f32 v214, v58, v214
    v_mul_f32 v215, v58, v215
    v_mul_f32 v216, v58, v216
    v_mul_f32 v217, v58, v217
    v_mul_f32 v218, v58, v218
    v_mul_f32 v219, v58, v219
    v_mul_f32 v220, v58, v220
    v_mul_f32 v221, v58, v221
    v_mul_f32 v222, v58, v222
    v_mul_f32 v223, v58, v223
    v_mul_f32 v224, v58, v224
    v_mul_f32 v225, v58, v225
    v_mul_f32 v226, v58, v226
    v_mul_f32 v227, v58, v227
    v_mul_f32 v228, v58, v228
    v_mul_f32 v229, v58, v229
    v_mul_f32 v230, v58, v230
    v_mul_f32 v231, v58, v231
    v_mul_f32 v232, v58, v232
    v_mul_f32 v233, v58, v233
    v_mul_f32 v234, v58, v234
    v_mul_f32 v235, v58, v235
    v_mul_f32 v236, v58, v236
    v_mul_f32 v237, v58, v237
    v_mul_f32 v238, v58, v238
    v_mul_f32 v239, v58, v239
    v_mul_f32 v240, v58, v240
    v_mul_f32 v241, v58, v241
    v_mul_f32 v242, v58, v242
    v_mul_f32 v243, v58, v243
    v_mul_f32 v244, v58, v244
    v_mul_f32 v245, v58, v245
    v_mul_f32 v246, v58, v246
    v_mul_f32 v247, v58, v247
    v_mul_f32 v248, v58, v248
    v_mul_f32 v249, v58, v249
    v_mul_f32 v250, v58, v250
    v_mul_f32 v251, v58, v251
    v_mul_f32 v252, v58, v252
    v_mul_f32 v253, v58, v253
    v_mul_f32 v254, v58, v254
    v_mul_f32 v255, v58, v255
    v_add_u32 v38, s68, v30
    v_add_u32 v39, s68, v31
    v_add_u32 v40, s68, v32
    v_add_u32 v41, s68, v33
    s_add_u32 s63, s64, s32
    s_waitcnt vmcnt(24)
    s_barrier
    ds_read_b64_tr_b16 a[64:65], v38 offset:0
    ds_read_b64_tr_b16 a[66:67], v38 offset:4096
    ds_read_b64_tr_b16 a[68:69], v39 offset:0
    ds_read_b64_tr_b16 a[70:71], v39 offset:4096
    ds_read_b64_tr_b16 a[72:73], v40 offset:0
    ds_read_b64_tr_b16 a[74:75], v40 offset:4096
    ds_read_b64_tr_b16 a[76:77], v41 offset:0
    ds_read_b64_tr_b16 a[78:79], v41 offset:4096
    ds_read_b64_tr_b16 a[80:81], v38 offset:256
    ds_read_b64_tr_b16 a[82:83], v38 offset:4352
    ds_read_b64_tr_b16 a[84:85], v39 offset:256
    ds_read_b64_tr_b16 a[86:87], v39 offset:4352
    s_waitcnt lgkmcnt(10)
    v_mfma_f32_32x32x16_bf16 v[128:143], a[64:67], v[80:83], v[128:143]
    ds_read_b64_tr_b16 a[88:89], v40 offset:256
    ds_read_b64_tr_b16 a[90:91], v40 offset:4352
    s_add_u32 m0, s63, 0x0
    s_add_u32 s61, s62, 0x0
    buffer_load_dwordx4 v20, s[16:19], s61 offen offset:0 nt lds
    s_waitcnt lgkmcnt(10)
    v_mfma_f32_32x32x16_bf16 v[144:159], a[68:71], v[80:83], v[144:159]
    ds_read_b64_tr_b16 a[92:93], v41 offset:256
    ds_read_b64_tr_b16 a[94:95], v41 offset:4352
    s_waitcnt lgkmcnt(10)
    v_mfma_f32_32x32x16_bf16 v[160:175], a[72:75], v[80:83], v[160:175]
    ds_read_b64_tr_b16 a[96:97], v38 offset:8192
    ds_read_b64_tr_b16 a[98:99], v38 offset:12288
    buffer_load_dwordx4 v21, s[16:19], s61 offen offset:1024 nt lds
    s_waitcnt lgkmcnt(10)
    v_mfma_f32_32x32x16_bf16 v[176:191], a[76:79], v[80:83], v[176:191]
    ds_read_b64_tr_b16 a[100:101], v39 offset:8192
    ds_read_b64_tr_b16 a[102:103], v39 offset:12288
    s_waitcnt lgkmcnt(10)
    v_mfma_f32_32x32x16_bf16 v[192:207], a[80:83], v[80:83], v[192:207]
    ds_read_b64_tr_b16 a[104:105], v40 offset:8192
    ds_read_b64_tr_b16 a[106:107], v40 offset:12288
    buffer_load_dwordx4 v20, s[16:19], s61 offen offset:2048 nt lds
    s_waitcnt lgkmcnt(10)
    v_mfma_f32_32x32x16_bf16 v[208:223], a[84:87], v[80:83], v[208:223]
    ds_read_b64_tr_b16 a[108:109], v41 offset:8192
    ds_read_b64_tr_b16 a[110:111], v41 offset:12288
    s_waitcnt lgkmcnt(10)
    v_mfma_f32_32x32x16_bf16 v[224:239], a[88:91], v[80:83], v[224:239]
    ds_read_b64_tr_b16 a[112:113], v38 offset:8448
    ds_read_b64_tr_b16 a[114:115], v38 offset:12544
    buffer_load_dwordx4 v21, s[16:19], s61 offen offset:3072 nt lds
    s_waitcnt lgkmcnt(10)
    v_mfma_f32_32x32x16_bf16 v[240:255], a[92:95], v[80:83], v[240:255]
    ds_read_b64_tr_b16 a[116:117], v39 offset:8448
    ds_read_b64_tr_b16 a[118:119], v39 offset:12544
    s_waitcnt lgkmcnt(10)
    v_mfma_f32_32x32x16_bf16 v[128:143], a[96:99], v[84:87], v[128:143]
    ds_read_b64_tr_b16 a[120:121], v40 offset:8448
    ds_read_b64_tr_b16 a[122:123], v40 offset:12544
    s_add_u32 m0, s63, 0x1000
    s_add_u32 s61, s62, 0x1000
    buffer_load_dwordx4 v20, s[16:19], s61 offen offset:0 nt lds
    s_waitcnt lgkmcnt(10)
    v_mfma_f32_32x32x16_bf16 v[144:159], a[100:103], v[84:87], v[144:159]
    ds_read_b64_tr_b16 a[124:125], v41 offset:8448
    ds_read_b64_tr_b16 a[126:127], v41 offset:12544
    s_waitcnt lgkmcnt(10)
    v_mfma_f32_32x32x16_bf16 v[160:175], a[104:107], v[84:87], v[160:175]
    ds_read_b64_tr_b16 a[64:65], v38 offset:16384
    ds_read_b64_tr_b16 a[66:67], v38 offset:20480
    buffer_load_dwordx4 v21, s[16:19], s61 offen offset:1024 nt lds
    s_waitcnt lgkmcnt(10)
    v_mfma_f32_32x32x16_bf16 v[176:191], a[108:111], v[84:87], v[176:191]
    ds_read_b64_tr_b16 a[68:69], v39 offset:16384
    ds_read_b64_tr_b16 a[70:71], v39 offset:20480
    s_waitcnt lgkmcnt(10)
    v_mfma_f32_32x32x16_bf16 v[192:207], a[112:115], v[84:87], v[192:207]
    ds_read_b64_tr_b16 a[72:73], v40 offset:16384
    ds_read_b64_tr_b16 a[74:75], v40 offset:20480
    buffer_load_dwordx4 v20, s[16:19], s61 offen offset:2048 nt lds
    s_waitcnt lgkmcnt(10)
    v_mfma_f32_32x32x16_bf16 v[208:223], a[116:119], v[84:87], v[208:223]
    ds_read_b64_tr_b16 a[76:77], v41 offset:16384
    ds_read_b64_tr_b16 a[78:79], v41 offset:20480
    s_waitcnt lgkmcnt(10)
    v_mfma_f32_32x32x16_bf16 v[224:239], a[120:123], v[84:87], v[224:239]
    ds_read_b64_tr_b16 a[80:81], v38 offset:16640
    ds_read_b64_tr_b16 a[82:83], v38 offset:20736
    buffer_load_dwordx4 v21, s[16:19], s61 offen offset:3072 nt lds
    s_waitcnt lgkmcnt(10)
    v_mfma_f32_32x32x16_bf16 v[240:255], a[124:127], v[84:87], v[240:255]
    ds_read_b64_tr_b16 a[84:85], v39 offset:16640
    ds_read_b64_tr_b16 a[86:87], v39 offset:20736
    s_waitcnt lgkmcnt(10)
    v_mfma_f32_32x32x16_bf16 v[128:143], a[64:67], v[88:91], v[128:143]
    ds_read_b64_tr_b16 a[88:89], v40 offset:16640
    ds_read_b64_tr_b16 a[90:91], v40 offset:20736
    s_waitcnt lgkmcnt(10)
    v_mfma_f32_32x32x16_bf16 v[144:159], a[68:71], v[88:91], v[144:159]
    ds_read_b64_tr_b16 a[92:93], v41 offset:16640
    ds_read_b64_tr_b16 a[94:95], v41 offset:20736
    s_waitcnt lgkmcnt(10)
    v_mfma_f32_32x32x16_bf16 v[160:175], a[72:75], v[88:91], v[160:175]
    ds_read_b64_tr_b16 a[96:97], v38 offset:24576
    ds_read_b64_tr_b16 a[98:99], v38 offset:28672
    s_waitcnt lgkmcnt(10)
    v_mfma_f32_32x32x16_bf16 v[176:191], a[76:79], v[88:91], v[176:191]
    ds_read_b64_tr_b16 a[100:101], v39 offset:24576
    ds_read_b64_tr_b16 a[102:103], v39 offset:28672
    s_waitcnt lgkmcnt(10)
    v_mfma_f32_32x32x16_bf16 v[192:207], a[80:83], v[88:91], v[192:207]
    ds_read_b64_tr_b16 a[104:105], v40 offset:24576
    ds_read_b64_tr_b16 a[106:107], v40 offset:28672
    s_waitcnt lgkmcnt(10)
    v_mfma_f32_32x32x16_bf16 v[208:223], a[84:87], v[88:91], v[208:223]
    ds_read_b64_tr_b16 a[108:109], v41 offset:24576
    ds_read_b64_tr_b16 a[110:111], v41 offset:28672
    s_waitcnt lgkmcnt(10)
    v_mfma_f32_32x32x16_bf16 v[224:239], a[88:91], v[88:91], v[224:239]
    ds_read_b64_tr_b16 a[112:113], v38 offset:24832
    ds_read_b64_tr_b16 a[114:115], v38 offset:28928
    s_waitcnt lgkmcnt(10)
    v_mfma_f32_32x32x16_bf16 v[240:255], a[92:95], v[88:91], v[240:255]
    ds_read_b64_tr_b16 a[116:117], v39 offset:24832
    ds_read_b64_tr_b16 a[118:119], v39 offset:28928
    s_waitcnt lgkmcnt(10)
    v_mfma_f32_32x32x16_bf16 v[128:143], a[96:99], v[92:95], v[128:143]
    ds_read_b64_tr_b16 a[120:121], v40 offset:24832
    ds_read_b64_tr_b16 a[122:123], v40 offset:28928
    s_waitcnt lgkmcnt(10)
    v_mfma_f32_32x32x16_bf16 v[144:159], a[100:103], v[92:95], v[144:159]
    ds_read_b64_tr_b16 a[124:125], v41 offset:24832
    ds_read_b64_tr_b16 a[126:127], v41 offset:28928
    s_waitcnt lgkmcnt(10)
    v_mfma_f32_32x32x16_bf16 v[160:175], a[104:107], v[92:95], v[160:175]
    s_waitcnt lgkmcnt(8)
    v_mfma_f32_32x32x16_bf16 v[176:191], a[108:111], v[92:95], v[176:191]
    s_waitcnt lgkmcnt(6)
    v_mfma_f32_32x32x16_bf16 v[192:207], a[112:115], v[92:95], v[192:207]
    s_waitcnt lgkmcnt(4)
    v_mfma_f32_32x32x16_bf16 v[208:223], a[116:119], v[92:95], v[208:223]
    s_waitcnt lgkmcnt(2)
    v_mfma_f32_32x32x16_bf16 v[224:239], a[120:123], v[92:95], v[224:239]
    s_waitcnt lgkmcnt(0)
    v_mfma_f32_32x32x16_bf16 v[240:255], a[124:127], v[92:95], v[240:255]
    s_add_u32 s64, s64, 0x10000
    s_cmp_ge_u32 s64, 0x28000
    s_cselect_b32 s60, 0x28000, 0
    s_sub_u32 s64, s64, s60
    s_add_u32 s68, s68, 0x10000
    s_cmp_ge_u32 s68, 0x28000
    s_cselect_b32 s60, 0x28000, 0
    s_sub_u32 s68, s68, s60
    s_add_u32 s69, s69, 0x10000
    s_cmp_ge_u32 s69, 0x28000
    s_cselect_b32 s60, 0x28000, 0
    s_sub_u32 s69, s69, s60
    s_add_u32 s62, s62, 0x8000
    s_add_u32 s34, s34, 1
    s_cmp_lt_u32 s34, 14
    s_cbranch_scc1 L_loop
    v_add_u32 v38, s64, v22
    v_add_u32 v39, s64, v23
    v_add_u32 v40, s64, v24
    v_add_u32 v41, s64, v25
    v_add_u32 v42, s64, v26
    v_add_u32 v43, s64, v27
    v_add_u32 v44, s64, v28
    v_add_u32 v45, s64, v29
    s_waitcnt vmcnt(24)
    s_barrier
    ds_read_b128 a[64:67], v38 offset:0
    ds_read_b128 a[68:71], v38 offset:16384
    ds_read_b128 a[72:75], v39 offset:0
    ds_read_b128 a[76:79], v39 offset:16384
    ds_read_b128 a[80:83], v40 offset:0
    ds_read_b128 a[84:87], v40 offset:16384
    ds_read_b128 a[88:91], v41 offset:0
    ds_read_b128 a[92:95], v41 offset:16384
    s_waitcnt lgkmcnt(7)
    v_mfma_f32_32x32x16_bf16 v[96:111], a[64:67], a[0:3], 0
    ds_read_b128 a[96:99], v42 offset:0
    s_add_u32 m0, s32, 0x10000
    s_nop 0
    buffer_load_dwordx4 v8, s[24:27], s59 offen offset:0 lds
    s_waitcnt lgkmcnt(7)
    v_mfma_f32_32x32x16_bf16 v[112:127], a[68:71], a[0:3], 0
    ds_read_b128 a[100:103], v42 offset:16384
    s_waitcnt lgkmcnt(7)
    v_mfma_f32_32x32x16_bf16 v[96:111], a[72:75], a[4:7], v[96:111]
    ds_read_b128 a[104:107], v43 offset:0
    buffer_load_dwordx4 v9, s[24:27], s59 offen offset:1024 lds
    s_waitcnt lgkmcnt(7)
    v_mfma_f32_32x32x16_bf16 v[112:127], a[76:79], a[4:7], v[112:127]
    ds_read_b128 a[108:111], v43 offset:16384
    s_waitcnt lgkmcnt(7)
    v_mfma_f32_32x32x16_bf16 v[96:111], a[80:83], a[8:11], v[96:111]
    ds_read_b128 a[112:115], v44 offset:0
    buffer_load_dwordx4 v10, s[24:27], s59 offen offset:2048 lds
    s_waitcnt lgkmcnt(7)
    v_mfma_f32_32x32x16_bf16 v[112:127], a[84:87], a[8:11], v[112:127]
    ds_read_b128 a[116:119], v44 offset:16384
    s_waitcnt lgkmcnt(7)
    v_mfma_f32_32x32x16_bf16 v[96:111], a[88:91], a[12:15], v[96:111]
    ds_read_b128 a[120:123], v45 offset:0
    buffer_load_dwordx4 v11, s[24:27], s59 offen offset:3072 lds
    s_waitcnt lgkmcnt(7)
    v_mfma_f32_32x32x16_bf16 v[112:127], a[92:95], a[12:15], v[112:127]
    ds_read_b128 a[124:127], v45 offset:16384
    s_waitcnt lgkmcnt(7)
    v_mfma_f32_32x32x16_bf16 v[96:111], a[96:99], a[16:19], v[96:111]
    ds_read_b128 a[64:67], v38 offset:256
    s_add_u32 m0, s32, 0x11000
    s_nop 0
    buffer_load_dwordx4 v68, s[24:27], s59 offen offset:0 lds
    s_waitcnt lgkmcnt(7)
    v_mfma_f32_32x32x16_bf16 v[112:127], a[100:103], a[16:19], v[112:127]
    ds_read_b128 a[68:71], v38 offset:16640
    s_waitcnt lgkmcnt(7)
    v_mfma_f32_32x32x16_bf16 v[96:111], a[104:107], a[20:23], v[96:111]
    ds_read_b128 a[72:75], v39 offset:256
    buffer_load_dwordx4 v69, s[24:27], s59 offen offset:1024 lds
    s_waitcnt lgkmcnt(7)
    v_mfma_f32_32x32x16_bf16 v[112:127], a[108:111], a[20:23], v[112:127]
    ds_read_b128 a[76:79], v39 offset:16640
    s_waitcnt lgkmcnt(7)
    v_mfma_f32_32x32x16_bf16 v[96:111], a[112:115], a[24:27], v[96:111]
    ds_read_b128 a[80:83], v40 offset:256
    buffer_load_dwordx4 v70, s[24:27], s59 offen offset:2048 lds
    s_waitcnt lgkmcnt(7)
    v_mfma_f32_32x32x16_bf16 v[112:127], a[116:119], a[24:27], v[112:127]
    ds_read_b128 a[84:87], v40 offset:16640
    s_waitcnt lgkmcnt(7)
    v_mfma_f32_32x32x16_bf16 v[96:111], a[120:123], a[28:31], v[96:111]
    ds_read_b128 a[88:91], v41 offset:256
    buffer_load_dwordx4 v71, s[24:27], s59 offen offset:3072 lds
    s_add_u32 s59, s59, 0x7000
    s_cmp_ge_u32 s59, s74
    s_cselect_b32 s60, 0x70000, 0
    s_sub_u32 s59, s59, s60
    s_waitcnt lgkmcnt(7)
    v_mfma_f32_32x32x16_bf16 v[112:127], a[124:127], a[28:31], v[112:127]
    ds_read_b128 a[92:95], v41 offset:16640
    s_waitcnt lgkmcnt(7)
    v_mfma_f32_32x32x16_bf16 v[96:111], a[64:67], a[32:35], v[96:111]
    ds_read_b128 a[96:99], v42 offset:256
    s_waitcnt lgkmcnt(7)
    v_mfma_f32_32x32x16_bf16 v[112:127], a[68:71], a[32:35], v[112:127]
    ds_read_b128 a[100:103], v42 offset:16640
    s_waitcnt lgkmcnt(7)
    v_mfma_f32_32x32x16_bf16 v[96:111], a[72:75], a[36:39], v[96:111]
    ds_read_b128 a[104:107], v43 offset:256
    s_waitcnt lgkmcnt(7)
    v_mfma_f32_32x32x16_bf16 v[112:127], a[76:79], a[36:39], v[112:127]
    ds_read_b128 a[108:111], v43 offset:16640
    s_waitcnt lgkmcnt(7)
    v_mfma_f32_32x32x16_bf16 v[96:111], a[80:83], a[40:43], v[96:111]
    ds_read_b128 a[112:115], v44 offset:256
    s_waitcnt lgkmcnt(7)
    v_mfma_f32_32x32x16_bf16 v[112:127], a[84:87], a[40:43], v[112:127]
    ds_read_b128 a[116:119], v44 offset:16640
    s_waitcnt lgkmcnt(7)
    v_mfma_f32_32x32x16_bf16 v[96:111], a[88:91], a[44:47], v[96:111]
    ds_read_b128 a[120:123], v45 offset:256
    s_waitcnt lgkmcnt(7)
    v_mfma_f32_32x32x16_bf16 v[112:127], a[92:95], a[44:47], v[112:127]
    ds_read_b128 a[124:127], v45 offset:16640
    s_waitcnt lgkmcnt(7)
    v_mfma_f32_32x32x16_bf16 v[96:111], a[96:99], a[48:51], v[96:111]
    s_waitcnt lgkmcnt(6)
    v_mfma_f32_32x32x16_bf16 v[112:127], a[100:103], a[48:51], v[112:127]
    s_waitcnt lgkmcnt(5)
    v_mfma_f32_32x32x16_bf16 v[96:111], a[104:107], a[52:55], v[96:111]
    s_waitcnt lgkmcnt(4)
    v_mfma_f32_32x32x16_bf16 v[112:127], a[108:111], a[52:55], v[112:127]
    s_waitcnt lgkmcnt(3)
    v_mfma_f32_32x32x16_bf16 v[96:111], a[112:115], a[56:59], v[96:111]
    s_waitcnt lgkmcnt(2)
    v_mfma_f32_32x32x16_bf16 v[112:127], a[116:119], a[56:59], v[112:127]
    s_waitcnt lgkmcnt(1)
    v_mfma_f32_32x32x16_bf16 v[96:111], a[120:123], a[60:63], v[96:111]
    s_waitcnt lgkmcnt(0)
    v_mfma_f32_32x32x16_bf16 v[112:127], a[124:127], a[60:63], v[112:127]
    s_nop 15
    v_max3_f32 v60, v96, v97, v98
    v_max3_f32 v61, v99, v100, v101
    v_max3_f32 v60, v60, v102, v103
    v_max3_f32 v61, v61, v104, v105
    v_max3_f32 v60, v60, v106, v107
    v_max3_f32 v61, v61, v108, v109
    v_max3_f32 v60, v60, v110, v111
    v_max3_f32 v61, v61, v112, v113
    v_max3_f32 v60, v60, v114, v115
    v_max3_f32 v61, v61, v116, v117
    v_max3_f32 v60, v60, v118, v119
    v_max3_f32 v61, v61, v120, v121
    v_max3_f32 v60, v60, v122, v123
    v_max3_f32 v61, v61, v124, v125
    v_max3_f32 v60, v60, v126, v127
    v_max_f32 v60, v60, v61
    v_mov_b32 v61, v60
    s_nop 1
    v_permlane32_swap_b32 v60, v61
    v_max3_f32 v60, v60, v61, v56
    v_sub_f32 v58, v56, v60
    v_mul_f32 v58, s35, v58
    v_exp_f32 v58, v58
    v_mov_b32 v56, v60
    v_mul_f32 v59, s35, v60
    v_sub_f32 v59, 0, v59
    v_fma_f32 v96, v96, s35, v59
    v_fma_f32 v97, v97, s35, v59
    v_fma_f32 v98, v98, s35, v59
    v_fma_f32 v99, v99, s35, v59
    v_fma_f32 v100, v100, s35, v59
    v_fma_f32 v101, v101, s35, v59
    v_fma_f32 v102, v102, s35, v59
    v_fma_f32 v103, v103, s35, v59
    v_fma_f32 v104, v104, s35, v59
    v_fma_f32 v105, v105, s35, v59
    v_fma_f32 v106, v106, s35, v59
    v_fma_f32 v107, v107, s35, v59
    v_fma_f32 v108, v108, s35, v59
    v_fma_f32 v109, v109, s35, v59
    v_fma_f32 v110, v110, s35, v59
    v_fma_f32 v111, v111, s35, v59
    v_fma_f32 v112, v112, s35, v59
    v_fma_f32 v113, v113, s35, v59
    v_fma_f32 v114, v114, s35, v59
    v_fma_f32 v115, v115, s35, v59
    v_fma_f32 v116, v116, s35, v59
    v_fma_f32 v117, v117, s35, v59
    v_fma_f32 v118, v118, s35, v59
    v_fma_f32 v119, v119, s35, v59
    v_fma_f32 v120, v120, s35, v59
    v_fma_f32 v121, v121, s35, v59
    v_fma_f32 v122, v122, s35, v59
    v_fma_f32 v123, v123, s35, v59
    v_fma_f32 v124, v124, s35, v59
    v_fma_f32 v125, v125, s35, v59
    v_fma_f32 v126, v126, s35, v59
    v_fma_f32 v127, v127, s35, v59
    v_exp_f32 v96, v96
    v_exp_f32 v97, v97
    v_exp_f32 v98, v98
    v_exp_f32 v99, v99
    v_exp_f32 v100, v100
    v_exp_f32 v101, v101
    v_exp_f32 v102, v102
    v_exp_f32 v103, v103
    v_exp_f32 v104, v104
    v_exp_f32 v105, v105
    v_exp_f32 v106, v106
    v_exp_f32 v107, v107
    v_exp_f32 v108, v108
    v_exp_f32 v109, v109
    v_exp_f32 v110, v110
    v_exp_f32 v111, v111
    v_exp_f32 v112, v112
    v_exp_f32 v113, v113
    v_exp_f32 v114, v114
    v_exp_f32 v115, v115
    v_exp_f32 v116, v116
    v_exp_f32 v117, v117
    v_exp_f32 v118, v118
    v_exp_f32 v119, v119
    v_exp_f32 v120, v120
    v_exp_f32 v121, v121
    v_exp_f32 v122, v122
    v_exp_f32 v123, v123
    v_exp_f32 v124, v124
    v_exp_f32 v125, v125
    v_exp_f32 v126, v126
    v_exp_f32 v127, v127
    v_mul_f32 v57, v57, v58
    v_add_f32 v64, v96, v100
    v_add_f32 v65, v97, v101
    v_add_f32 v66, v98, v102
    v_add_f32 v67, v99, v103
    v_add_f32 v64, v64, v104
    v_add_f32 v65, v65, v105
    v_add_f32 v66, v66, v106
    v_add_f32 v67, v67, v107
    v_add_f32 v64, v64, v108
    v_add_f32 v65, v65, v109
    v_add_f32 v66, v66, v110
    v_add_f32 v67, v67, v111
    v_add_f32 v64, v64, v112
    v_add_f32 v65, v65, v113
    v_add_f32 v66, v66, v114
    v_add_f32 v67, v67, v115
    v_add_f32 v64, v64, v116
    v_add_f32 v65, v65, v117
    v_add_f32 v66, v66, v118
    v_add_f32 v67, v67, v119
    v_add_f32 v64, v64, v120
    v_add_f32 v65, v65, v121
    v_add_f32 v66, v66, v122
    v_add_f32 v67, v67, v123
    v_add_f32 v64, v64, v124
    v_add_f32 v65, v65, v125
    v_add_f32 v66, v66, v126
    v_add_f32 v67, v67, v127
    v_add_f32 v64, v64, v65
    v_add_f32 v66, v66, v67
    v_add_f32 v64, v64, v66
    v_add_f32 v57, v57, v64
    v_cvt_pk_bf16_f32 v80, v96, v97
    v_cvt_pk_bf16_f32 v81, v98, v99
    v_cvt_pk_bf16_f32 v82, v100, v101
    v_cvt_pk_bf16_f32 v83, v102, v103
    v_cvt_pk_bf16_f32 v84, v104, v105
    v_cvt_pk_bf16_f32 v85, v106, v107
    v_cvt_pk_bf16_f32 v86, v108, v109
    v_cvt_pk_bf16_f32 v87, v110, v111
    v_cvt_pk_bf16_f32 v88, v112, v113
    v_cvt_pk_bf16_f32 v89, v114, v115
    v_cvt_pk_bf16_f32 v90, v116, v117
    v_cvt_pk_bf16_f32 v91, v118, v119
    v_cvt_pk_bf16_f32 v92, v120, v121
    v_cvt_pk_bf16_f32 v93, v122, v123
    v_cvt_pk_bf16_f32 v94, v124, v125
    v_cvt_pk_bf16_f32 v95, v126, v127
    v_mul_f32 v128, v58, v128
    v_mul_f32 v129, v58, v129
    v_mul_f32 v130, v58, v130
    v_mul_f32 v131, v58, v131
    v_mul_f32 v132, v58, v132
    v_mul_f32 v133, v58, v133
    v_mul_f32 v134, v58, v134
    v_mul_f32 v135, v58, v135
    v_mul_f32 v136, v58, v136
    v_mul_f32 v137, v58, v137
    v_mul_f32 v138, v58, v138
    v_mul_f32 v139, v58, v139
    v_mul_f32 v140, v58, v140
    v_mul_f32 v141, v58, v141
    v_mul_f32 v142, v58, v142
    v_mul_f32 v143, v58, v143
    v_mul_f32 v144, v58, v144
    v_mul_f32 v145, v58, v145
    v_mul_f32 v146, v58, v146
    v_mul_f32 v147, v58, v147
    v_mul_f32 v148, v58, v148
    v_mul_f32 v149, v58, v149
    v_mul_f32 v150, v58, v150
    v_mul_f32 v151, v58, v151
    v_mul_f32 v152, v58, v152
    v_mul_f32 v153, v58, v153
    v_mul_f32 v154, v58, v154
    v_mul_f32 v155, v58, v155
    v_mul_f32 v156, v58, v156
    v_mul_f32 v157, v58, v157
    v_mul_f32 v158, v58, v158
    v_mul_f32 v159, v58, v159
    v_mul_f32 v160, v58, v160
    v_mul_f32 v161, v58, v161
    v_mul_f32 v162, v58, v162
    v_mul_f32 v163, v58, v163
    v_mul_f32 v164, v58, v164
    v_mul_f32 v165, v58, v165
    v_mul_f32 v166, v58, v166
    v_mul_f32 v167, v58, v167
    v_mul_f32 v168, v58, v168
    v_mul_f32 v169, v58, v169
    v_mul_f32 v170, v58, v170
    v_mul_f32 v171, v58, v171
    v_mul_f32 v172, v58, v172
    v_mul_f32 v173, v58, v173
    v_mul_f32 v174, v58, v174
    v_mul_f32 v175, v58, v175
    v_mul_f32 v176, v58, v176
    v_mul_f32 v177, v58, v177
    v_mul_f32 v178, v58, v178
    v_mul_f32 v179, v58, v179
    v_mul_f32 v180, v58, v180
    v_mul_f32 v181, v58, v181
    v_mul_f32 v182, v58, v182
    v_mul_f32 v183, v58, v183
    v_mul_f32 v184, v58, v184
    v_mul_f32 v185, v58, v185
    v_mul_f32 v186, v58, v186
    v_mul_f32 v187, v58, v187
    v_mul_f32 v188, v58, v188
    v_mul_f32 v189, v58, v189
    v_mul_f32 v190, v58, v190
    v_mul_f32 v191, v58, v191
    v_mul_f32 v192, v58, v192
    v_mul_f32 v193, v58, v193
    v_mul_f32 v194, v58, v194
    v_mul_f32 v195, v58, v195
    v_mul_f32 v196, v58, v196
    v_mul_f32 v197, v58, v197
    v_mul_f32 v198, v58, v198
    v_mul_f32 v199, v58, v199
    v_mul_f32 v200, v58, v200
    v_mul_f32 v201, v58, v201
    v_mul_f32 v202, v58, v202
    v_mul_f32 v203, v58, v203
    v_mul_f32 v204, v58, v204
    v_mul_f32 v205, v58, v205
    v_mul_f32 v206, v58, v206
    v_mul_f32 v207, v58, v207
    v_mul_f32 v208, v58, v208
    v_mul_f32 v209, v58, v209
    v_mul_f32 v210, v58, v210
    v_mul_f32 v211, v58, v211
    v_mul_f32 v212, v58, v212
    v_mul_f32 v213, v58, v213
    v_mul_f32 v214, v58, v214
    v_mul_f32 v215, v58, v215
    v_mul_f32 v216, v58, v216
    v_mul_f32 v217, v58, v217
    v_mul_f32 v218, v58, v218
    v_mul_f32 v219, v58, v219
    v_mul_f32 v220, v58, v220
    v_mul_f32 v221, v58, v221
    v_mul_f32 v222, v58, v222
    v_mul_f32 v223, v58, v223
    v_mul_f32 v224, v58, v224
    v_mul_f32 v225, v58, v225
    v_mul_f32 v226, v58, v226
    v_mul_f32 v227, v58, v227
    v_mul_f32 v228, v58, v228
    v_mul_f32 v229, v58, v229
    v_mul_f32 v230, v58, v230
    v_mul_f32 v231, v58, v231
    v_mul_f32 v232, v58, v232
    v_mul_f32 v233, v58, v233
    v_mul_f32 v234, v58, v234
    v_mul_f32 v235, v58, v235
    v_mul_f32 v236, v58, v236
    v_mul_f32 v237, v58, v237
    v_mul_f32 v238, v58, v238
    v_mul_f32 v239, v58, v239
    v_mul_f32 v240, v58, v240
    v_mul_f32 v241, v58, v241
    v_mul_f32 v242, v58, v242
    v_mul_f32 v243, v58, v243
    v_mul_f32 v244, v58, v244
    v_mul_f32 v245, v58, v245
    v_mul_f32 v246, v58, v246
    v_mul_f32 v247, v58, v247
    v_mul_f32 v248, v58, v248
    v_mul_f32 v249, v58, v249
    v_mul_f32 v250, v58, v250
    v_mul_f32 v251, v58, v251
    v_mul_f32 v252, v58, v252
    v_mul_f32 v253, v58, v253
    v_mul_f32 v254, v58, v254
    v_mul_f32 v255, v58, v255
    v_add_u32 v38, s68, v30
    v_add_u32 v39, s68, v31
    v_add_u32 v40, s68, v32
    v_add_u32 v41, s68, v33
    s_add_u32 s63, s64, s32
    s_waitcnt vmcnt(24)
    s_barrier
    ds_read_b64_tr_b16 a[64:65], v38 offset:0
    ds_read_b64_tr_b16 a[66:67], v38 offset:4096
    ds_read_b64_tr_b16 a[68:69], v39 offset:0
    ds_read_b64_tr_b16 a[70:71], v39 offset:4096
    ds_read_b64_tr_b16 a[72:73], v40 offset:0
    ds_read_b64_tr_b16 a[74:75], v40 offset:4096
    ds_read_b64_tr_b16 a[76:77], v41 offset:0
    ds_read_b64_tr_b16 a[78:79], v41 offset:4096
    ds_read_b64_tr_b16 a[80:81], v38 offset:256
    ds_read_b64_tr_b16 a[82:83], v38 offset:4352
    ds_read_b64_tr_b16 a[84:85], v39 offset:256
    ds_read_b64_tr_b16 a[86:87], v39 offset:4352
    s_waitcnt lgkmcnt(10)
    v_mfma_f32_32x32x16_bf16 v[128:143], a[64:67], v[80:83], v[128:143]
    ds_read_b64_tr_b16 a[88:89], v40 offset:256
    ds_read_b64_tr_b16 a[90:91], v40 offset:4352
    s_add_u32 m0, s32, 0x18000
    s_nop 0
    buffer_load_dwordx4 v8, s[24:27], s59 offen offset:0 lds
    s_waitcnt lgkmcnt(10)
    v_mfma_f32_32x32x16_bf16 v[144:159], a[68:71], v[80:83], v[144:159]
    ds_read_b64_tr_b16 a[92:93], v41 offset:256
    ds_read_b64_tr_b16 a[94:95], v41 offset:4352
    s_waitcnt lgkmcnt(10)
    v_mfma_f32_32x32x16_bf16 v[160:175], a[72:75], v[80:83], v[160:175]
    ds_read_b64_tr_b16 a[96:97], v38 offset:8192
    ds_read_b64_tr_b16 a[98:99], v38 offset:12288
    buffer_load_dwordx4 v9, s[24:27], s59 offen offset:1024 lds
    s_waitcnt lgkmcnt(10)
    v_mfma_f32_32x32x16_bf16 v[176:191], a[76:79], v[80:83], v[176:191]
    ds_read_b64_tr_b16 a[100:101], v39 offset:8192
    ds_read_b64_tr_b16 a[102:103], v39 offset:12288
    s_waitcnt lgkmcnt(10)
    v_mfma_f32_32x32x16_bf16 v[192:207], a[80:83], v[80:83], v[192:207]
    ds_read_b64_tr_b16 a[104:105], v40 offset:8192
    ds_read_b64_tr_b16 a[106:107], v40 offset:12288
    buffer_load_dwordx4 v10, s[24:27], s59 offen offset:2048 lds
    s_waitcnt lgkmcnt(10)
    v_mfma_f32_32x32x16_bf16 v[208:223], a[84:87], v[80:83], v[208:223]
    ds_read_b64_tr_b16 a[108:109], v41 offset:8192
    ds_read_b64_tr_b16 a[110:111], v41 offset:12288
    s_waitcnt lgkmcnt(10)
    v_mfma_f32_32x32x16_bf16 v[224:239], a[88:91], v[80:83], v[224:239]
    ds_read_b64_tr_b16 a[112:113], v38 offset:8448
    ds_read_b64_tr_b16 a[114:115], v38 offset:12544
    buffer_load_dwordx4 v11, s[24:27], s59 offen offset:3072 lds
    s_waitcnt lgkmcnt(10)
    v_mfma_f32_32x32x16_bf16 v[240:255], a[92:95], v[80:83], v[240:255]
    ds_read_b64_tr_b16 a[116:117], v39 offset:8448
    ds_read_b64_tr_b16 a[118:119], v39 offset:12544
    s_waitcnt lgkmcnt(10)
    v_mfma_f32_32x32x16_bf16 v[128:143], a[96:99], v[84:87], v[128:143]
    ds_read_b64_tr_b16 a[120:121], v40 offset:8448
    ds_read_b64_tr_b16 a[122:123], v40 offset:12544
    s_add_u32 m0, s32, 0x19000
    s_nop 0
    buffer_load_dwordx4 v68, s[24:27], s59 offen offset:0 lds
    s_waitcnt lgkmcnt(10)
    v_mfma_f32_32x32x16_bf16 v[144:159], a[100:103], v[84:87], v[144:159]
    ds_read_b64_tr_b16 a[124:125], v41 offset:8448
    ds_read_b64_tr_b16 a[126:127], v41 offset:12544
    s_waitcnt lgkmcnt(10)
    v_mfma_f32_32x32x16_bf16 v[160:175], a[104:107], v[84:87], v[160:175]
    ds_read_b64_tr_b16 a[64:65], v38 offset:16384
    ds_read_b64_tr_b16 a[66:67], v38 offset:20480
    buffer_load_dwordx4 v69, s[24:27], s59 offen offset:1024 lds
    s_waitcnt lgkmcnt(10)
    v_mfma_f32_32x32x16_bf16 v[176:191], a[108:111], v[84:87], v[176:191]
    ds_read_b64_tr_b16 a[68:69], v39 offset:16384
    ds_read_b64_tr_b16 a[70:71], v39 offset:20480
    s_waitcnt lgkmcnt(10)
    v_mfma_f32_32x32x16_bf16 v[192:207], a[112:115], v[84:87], v[192:207]
    ds_read_b64_tr_b16 a[72:73], v40 offset:16384
    ds_read_b64_tr_b16 a[74:75], v40 offset:20480
    buffer_load_dwordx4 v70, s[24:27], s59 offen offset:2048 lds
    s_waitcnt lgkmcnt(10)
    v_mfma_f32_32x32x16_bf16 v[208:223], a[116:119], v[84:87], v[208:223]
    ds_read_b64_tr_b16 a[76:77], v41 offset:16384
    ds_read_b64_tr_b16 a[78:79], v41 offset:20480
    s_waitcnt lgkmcnt(10)
    v_mfma_f32_32x32x16_bf16 v[224:239], a[120:123], v[84:87], v[224:239]
    ds_read_b64_tr_b16 a[80:81], v38 offset:16640
    ds_read_b64_tr_b16 a[82:83], v38 offset:20736
    buffer_load_dwordx4 v71, s[24:27], s59 offen offset:3072 lds
    s_add_u32 s59, s59, 0x7000
    s_cmp_ge_u32 s59, s74
    s_cselect_b32 s60, 0x70000, 0
    s_sub_u32 s59, s59, s60
    s_waitcnt lgkmcnt(10)
    v_mfma_f32_32x32x16_bf16 v[240:255], a[124:127], v[84:87], v[240:255]
    ds_read_b64_tr_b16 a[84:85], v39 offset:16640
    ds_read_b64_tr_b16 a[86:87], v39 offset:20736
    s_waitcnt lgkmcnt(10)
    v_mfma_f32_32x32x16_bf16 v[128:143], a[64:67], v[88:91], v[128:143]
    ds_read_b64_tr_b16 a[88:89], v40 offset:16640
    ds_read_b64_tr_b16 a[90:91], v40 offset:20736
    s_waitcnt lgkmcnt(10)
    v_mfma_f32_32x32x16_bf16 v[144:159], a[68:71], v[88:91], v[144:159]
    ds_read_b64_tr_b16 a[92:93], v41 offset:16640
    ds_read_b64_tr_b16 a[94:95], v41 offset:20736
    s_waitcnt lgkmcnt(10)
    v_mfma_f32_32x32x16_bf16 v[160:175], a[72:75], v[88:91], v[160:175]
    ds_read_b64_tr_b16 a[96:97], v38 offset:24576
    ds_read_b64_tr_b16 a[98:99], v38 offset:28672
    s_waitcnt lgkmcnt(10)
    v_mfma_f32_32x32x16_bf16 v[176:191], a[76:79], v[88:91], v[176:191]
    ds_read_b64_tr_b16 a[100:101], v39 offset:24576
    ds_read_b64_tr_b16 a[102:103], v39 offset:28672
    s_waitcnt lgkmcnt(10)
    v_mfma_f32_32x32x16_bf16 v[192:207], a[80:83], v[88:91], v[192:207]
    ds_read_b64_tr_b16 a[104:105], v40 offset:24576
    ds_read_b64_tr_b16 a[106:107], v40 offset:28672
    s_waitcnt lgkmcnt(10)
    v_mfma_f32_32x32x16_bf16 v[208:223], a[84:87], v[88:91], v[208:223]
    ds_read_b64_tr_b16 a[108:109], v41 offset:24576
    ds_read_b64_tr_b16 a[110:111], v41 offset:28672
    s_waitcnt lgkmcnt(10)
    v_mfma_f32_32x32x16_bf16 v[224:239], a[88:91], v[88:91], v[224:239]
    ds_read_b64_tr_b16 a[112:113], v38 offset:24832
    ds_read_b64_tr_b16 a[114:115], v38 offset:28928
    s_waitcnt lgkmcnt(10)
    v_mfma_f32_32x32x16_bf16 v[240:255], a[92:95], v[88:91], v[240:255]
    ds_read_b64_tr_b16 a[116:117], v39 offset:24832
    ds_read_b64_tr_b16 a[118:119], v39 offset:28928
    s_waitcnt lgkmcnt(10)
    v_mfma_f32_32x32x16_bf16 v[128:143], a[96:99], v[92:95], v[128:143]
    ds_read_b64_tr_b16 a[120:121], v40 offset:24832
    ds_read_b64_tr_b16 a[122:123], v40 offset:28928
    s_waitcnt lgkmcnt(10)
    v_mfma_f32_32x32x16_bf16 v[144:159], a[100:103], v[92:95], v[144:159]
    ds_read_b64_tr_b16 a[124:125], v41 offset:24832
    ds_read_b64_tr_b16 a[126:127], v41 offset:28928
    s_waitcnt lgkmcnt(10)
    v_mfma_f32_32x32x16_bf16 v[160:175], a[104:107], v[92:95], v[160:175]
    s_waitcnt lgkmcnt(8)
    v_mfma_f32_32x32x16_bf16 v[176:191], a[108:111], v[92:95], v[176:191]
    s_waitcnt lgkmcnt(6)
    v_mfma_f32_32x32x16_bf16 v[192:207], a[112:115], v[92:95], v[192:207]
    s_waitcnt lgkmcnt(4)
    v_mfma_f32_32x32x16_bf16 v[208:223], a[116:119], v[92:95], v[208:223]
    s_waitcnt lgkmcnt(2)
    v_mfma_f32_32x32x16_bf16 v[224:239], a[120:123], v[92:95], v[224:239]
    s_waitcnt lgkmcnt(0)
    v_mfma_f32_32x32x16_bf16 v[240:255], a[124:127], v[92:95], v[240:255]
    s_add_u32 s64, s64, 0x10000
    s_cmp_ge_u32 s64, 0x28000
    s_cselect_b32 s60, 0x28000, 0
    s_sub_u32 s64, s64, s60
    s_add_u32 s68, s68, 0x10000
    s_cmp_ge_u32 s68, 0x28000
    s_cselect_b32 s60, 0x28000, 0
    s_sub_u32 s68, s68, s60
    s_add_u32 s69, s69, 0x10000
    s_cmp_ge_u32 s69, 0x28000
    s_cselect_b32 s60, 0x28000, 0
    s_sub_u32 s69, s69, s60
    s_add_u32 s62, s62, 0x8000
    v_add_u32 v38, s64, v22
    v_add_u32 v39, s64, v23
    v_add_u32 v40, s64, v24
    v_add_u32 v41, s64, v25
    v_add_u32 v42, s64, v26
    v_add_u32 v43, s64, v27
    v_add_u32 v44, s64, v28
    v_add_u32 v45, s64, v29
    s_waitcnt vmcnt(24)
    s_barrier
    ds_read_b128 a[64:67], v38 offset:0
    ds_read_b128 a[68:71], v38 offset:16384
    ds_read_b128 a[72:75], v39 offset:0
    ds_read_b128 a[76:79], v39 offset:16384
    ds_read_b128 a[80:83], v40 offset:0
    ds_read_b128 a[84:87], v40 offset:16384
    ds_read_b128 a[88:91], v41 offset:0
    ds_read_b128 a[92:95], v41 offset:16384
    s_waitcnt lgkmcnt(7)
    v_mfma_f32_32x32x16_bf16 v[96:111], a[64:67], a[0:3], 0
    ds_read_b128 a[96:99], v42 offset:0
    s_add_u32 m0, s32, 0x20000
    s_nop 0
    buffer_load_dwordx4 v8, s[24:27], s59 offen offset:0 lds
    s_waitcnt lgkmcnt(7)
    v_mfma_f32_32x32x16_bf16 v[112:127], a[68:71], a[0:3], 0
    ds_read_b128 a[100:103], v42 offset:16384
    s_waitcnt lgkmcnt(7)
    v_mfma_f32_32x32x16_bf16 v[96:111], a[72:75], a[4:7], v[96:111]
    ds_read_b128 a[104:107], v43 offset:0
    buffer_load_dwordx4 v9, s[24:27], s59 offen offset:1024 lds
    s_waitcnt lgkmcnt(7)
    v_mfma_f32_32x32x16_bf16 v[112:127], a[76:79], a[4:7], v[112:127]
    ds_read_b128 a[108:111], v43 offset:16384
    s_waitcnt lgkmcnt(7)
    v_mfma_f32_32x32x16_bf16 v[96:111], a[80:83], a[8:11], v[96:111]
    ds_read_b128 a[112:115], v44 offset:0
    buffer_load_dwordx4 v10, s[24:27], s59 offen offset:2048 lds
    s_waitcnt lgkmcnt(7)
    v_mfma_f32_32x32x16_bf16 v[112:127], a[84:87], a[8:11], v[112:127]
    ds_read_b128 a[116:119], v44 offset:16384
    s_waitcnt lgkmcnt(7)
    v_mfma_f32_32x32x16_bf16 v[96:111], a[88:91], a[12:15], v[96:111]
    ds_read_b128 a[120:123], v45 offset:0
    buffer_load_dwordx4 v11, s[24:27], s59 offen offset:3072 lds
    s_waitcnt lgkmcnt(7)
    v_mfma_f32_32x32x16_bf16 v[112:127], a[92:95], a[12:15], v[112:127]
    ds_read_b128 a[124:127], v45 offset:16384
    s_waitcnt lgkmcnt(7)
    v_mfma_f32_32x32x16_bf16 v[96:111], a[96:99], a[16:19], v[96:111]
    ds_read_b128 a[64:67], v38 offset:256
    s_add_u32 m0, s32, 0x21000
    s_nop 0
    buffer_load_dwordx4 v68, s[24:27], s59 offen offset:0 lds
    s_waitcnt lgkmcnt(7)
    v_mfma_f32_32x32x16_bf16 v[112:127], a[100:103], a[16:19], v[112:127]
    ds_read_b128 a[68:71], v38 offset:16640
    s_waitcnt lgkmcnt(7)
    v_mfma_f32_32x32x16_bf16 v[96:111], a[104:107], a[20:23], v[96:111]
    ds_read_b128 a[72:75], v39 offset:256
    buffer_load_dwordx4 v69, s[24:27], s59 offen offset:1024 lds
    s_waitcnt lgkmcnt(7)
    v_mfma_f32_32x32x16_bf16 v[112:127], a[108:111], a[20:23], v[112:127]
    ds_read_b128 a[76:79], v39 offset:16640
    s_waitcnt lgkmcnt(7)
    v_mfma_f32_32x32x16_bf16 v[96:111], a[112:115], a[24:27], v[96:111]
    ds_read_b128 a[80:83], v40 offset:256
    buffer_load_dwordx4 v70, s[24:27], s59 offen offset:2048 lds
    s_waitcnt lgkmcnt(7)
    v_mfma_f32_32x32x16_bf16 v[112:127], a[116:119], a[24:27], v[112:127]
    ds_read_b128 a[84:87], v40 offset:16640
    s_waitcnt lgkmcnt(7)
    v_mfma_f32_32x32x16_bf16 v[96:111], a[120:123], a[28:31], v[96:111]
    ds_read_b128 a[88:91], v41 offset:256
    buffer_load_dwordx4 v71, s[24:27], s59 offen offset:3072 lds
    s_add_u32 s59, s59, 0x7000
    s_cmp_ge_u32 s59, s74
    s_cselect_b32 s60, 0x70000, 0
    s_sub_u32 s59, s59, s60
    s_waitcnt lgkmcnt(7)
    v_mfma_f32_32x32x16_bf16 v[112:127], a[124:127], a[28:31], v[112:127]
    ds_read_b128 a[92:95], v41 offset:16640
    s_waitcnt lgkmcnt(7)
    v_mfma_f32_32x32x16_bf16 v[96:111], a[64:67], a[32:35], v[96:111]
    ds_read_b128 a[96:99], v42 offset:256
    s_waitcnt lgkmcnt(7)
    v_mfma_f32_32x32x16_bf16 v[112:127], a[68:71], a[32:35], v[112:127]
    ds_read_b128 a[100:103], v42 offset:16640
    s_waitcnt lgkmcnt(7)
    v_mfma_f32_32x32x16_bf16 v[96:111], a[72:75], a[36:39], v[96:111]
    ds_read_b128 a[104:107], v43 offset:256
    s_waitcnt lgkmcnt(7)
    v_mfma_f32_32x32x16_bf16 v[112:127], a[76:79], a[36:39], v[112:127]
    ds_read_b128 a[108:111], v43 offset:16640
    s_waitcnt lgkmcnt(7)
    v_mfma_f32_32x32x16_bf16 v[96:111], a[80:83], a[40:43], v[96:111]
    ds_read_b128 a[112:115], v44 offset:256
    s_waitcnt lgkmcnt(7)
    v_mfma_f32_32x32x16_bf16 v[112:127], a[84:87], a[40:43], v[112:127]
    ds_read_b128 a[116:119], v44 offset:16640
    s_waitcnt lgkmcnt(7)
    v_mfma_f32_32x32x16_bf16 v[96:111], a[88:91], a[44:47], v[96:111]
    ds_read_b128 a[120:123], v45 offset:256
    s_waitcnt lgkmcnt(7)
    v_mfma_f32_32x32x16_bf16 v[112:127], a[92:95], a[44:47], v[112:127]
    ds_read_b128 a[124:127], v45 offset:16640
    s_waitcnt lgkmcnt(7)
    v_mfma_f32_32x32x16_bf16 v[96:111], a[96:99], a[48:51], v[96:111]
    s_waitcnt lgkmcnt(6)
    v_mfma_f32_32x32x16_bf16 v[112:127], a[100:103], a[48:51], v[112:127]
    s_waitcnt lgkmcnt(5)
    v_mfma_f32_32x32x16_bf16 v[96:111], a[104:107], a[52:55], v[96:111]
    s_waitcnt lgkmcnt(4)
    v_mfma_f32_32x32x16_bf16 v[112:127], a[108:111], a[52:55], v[112:127]
    s_waitcnt lgkmcnt(3)
    v_mfma_f32_32x32x16_bf16 v[96:111], a[112:115], a[56:59], v[96:111]
    s_waitcnt lgkmcnt(2)
    v_mfma_f32_32x32x16_bf16 v[112:127], a[116:119], a[56:59], v[112:127]
    s_waitcnt lgkmcnt(1)
    v_mfma_f32_32x32x16_bf16 v[96:111], a[120:123], a[60:63], v[96:111]
    s_waitcnt lgkmcnt(0)
    v_mfma_f32_32x32x16_bf16 v[112:127], a[124:127], a[60:63], v[112:127]
    s_nop 15
    v_max3_f32 v60, v96, v97, v98
    v_max3_f32 v61, v99, v100, v101
    v_max3_f32 v60, v60, v102, v103
    v_max3_f32 v61, v61, v104, v105
    v_max3_f32 v60, v60, v106, v107
    v_max3_f32 v61, v61, v108, v109
    v_max3_f32 v60, v60, v110, v111
    v_max3_f32 v61, v61, v112, v113
    v_max3_f32 v60, v60, v114, v115
    v_max3_f32 v61, v61, v116, v117
    v_max3_f32 v60, v60, v118, v119
    v_max3_f32 v61, v61, v120, v121
    v_max3_f32 v60, v60, v122, v123
    v_max3_f32 v61, v61, v124, v125
    v_max3_f32 v60, v60, v126, v127
    v_max_f32 v60, v60, v61
    v_mov_b32 v61, v60
    s_nop 1
    v_permlane32_swap_b32 v60, v61
    v_max3_f32 v60, v60, v61, v56
    v_sub_f32 v58, v56, v60
    v_mul_f32 v58, s35, v58
    v_exp_f32 v58, v58
    v_mov_b32 v56, v60
    v_mul_f32 v59, s35, v60
    v_sub_f32 v59, 0, v59
    v_fma_f32 v96, v96, s35, v59
    v_fma_f32 v97, v97, s35, v59
    v_fma_f32 v98, v98, s35, v59
    v_fma_f32 v99, v99, s35, v59
    v_fma_f32 v100, v100, s35, v59
    v_fma_f32 v101, v101, s35, v59
    v_fma_f32 v102, v102, s35, v59
    v_fma_f32 v103, v103, s35, v59
    v_fma_f32 v104, v104, s35, v59
    v_fma_f32 v105, v105, s35, v59
    v_fma_f32 v106, v106, s35, v59
    v_fma_f32 v107, v107, s35, v59
    v_fma_f32 v108, v108, s35, v59
    v_fma_f32 v109, v109, s35, v59
    v_fma_f32 v110, v110, s35, v59
    v_fma_f32 v111, v111, s35, v59
    v_fma_f32 v112, v112, s35, v59
    v_fma_f32 v113, v113, s35, v59
    v_fma_f32 v114, v114, s35, v59
    v_fma_f32 v115, v115, s35, v59
    v_fma_f32 v116, v116, s35, v59
    v_fma_f32 v117, v117, s35, v59
    v_fma_f32 v118, v118, s35, v59
    v_fma_f32 v119, v119, s35, v59
    v_fma_f32 v120, v120, s35, v59
    v_fma_f32 v121, v121, s35, v59
    v_fma_f32 v122, v122, s35, v59
    v_fma_f32 v123, v123, s35, v59
    v_fma_f32 v124, v124, s35, v59
    v_fma_f32 v125, v125, s35, v59
    v_fma_f32 v126, v126, s35, v59
    v_fma_f32 v127, v127, s35, v59
    v_exp_f32 v96, v96
    v_exp_f32 v97, v97
    v_exp_f32 v98, v98
    v_exp_f32 v99, v99
    v_exp_f32 v100, v100
    v_exp_f32 v101, v101
    v_exp_f32 v102, v102
    v_exp_f32 v103, v103
    v_exp_f32 v104, v104
    v_exp_f32 v105, v105
    v_exp_f32 v106, v106
    v_exp_f32 v107, v107
    v_exp_f32 v108, v108
    v_exp_f32 v109, v109
    v_exp_f32 v110, v110
    v_exp_f32 v111, v111
    v_exp_f32 v112, v112
    v_exp_f32 v113, v113
    v_exp_f32 v114, v114
    v_exp_f32 v115, v115
    v_exp_f32 v116, v116
    v_exp_f32 v117, v117
    v_exp_f32 v118, v118
    v_exp_f32 v119, v119
    v_exp_f32 v120, v120
    v_exp_f32 v121, v121
    v_exp_f32 v122, v122
    v_exp_f32 v123, v123
    v_exp_f32 v124, v124
    v_exp_f32 v125, v125
    v_exp_f32 v126, v126
    v_exp_f32 v127, v127
    v_mul_f32 v57, v57, v58
    v_add_f32 v64, v96, v100
    v_add_f32 v65, v97, v101
    v_add_f32 v66, v98, v102
    v_add_f32 v67, v99, v103
    v_add_f32 v64, v64, v104
    v_add_f32 v65, v65, v105
    v_add_f32 v66, v66, v106
    v_add_f32 v67, v67, v107
    v_add_f32 v64, v64, v108
    v_add_f32 v65, v65, v109
    v_add_f32 v66, v66, v110
    v_add_f32 v67, v67, v111
    v_add_f32 v64, v64, v112
    v_add_f32 v65, v65, v113
    v_add_f32 v66, v66, v114
    v_add_f32 v67, v67, v115
    v_add_f32 v64, v64, v116
    v_add_f32 v65, v65, v117
    v_add_f32 v66, v66, v118
    v_add_f32 v67, v67, v119
    v_add_f32 v64, v64, v120
    v_add_f32 v65, v65, v121
    v_add_f32 v66, v66, v122
    v_add_f32 v67, v67, v123
    v_add_f32 v64, v64, v124
    v_add_f32 v65, v65, v125
    v_add_f32 v66, v66, v126
    v_add_f32 v67, v67, v127
    v_add_f32 v64, v64, v65
    v_add_f32 v66, v66, v67
    v_add_f32 v64, v64, v66
    v_add_f32 v57, v57, v64
    v_cvt_pk_bf16_f32 v80, v96, v97
    v_cvt_pk_bf16_f32 v81, v98, v99
    v_cvt_pk_bf16_f32 v82, v100, v101
    v_cvt_pk_bf16_f32 v83, v102, v103
    v_cvt_pk_bf16_f32 v84, v104, v105
    v_cvt_pk_bf16_f32 v85, v106, v107
    v_cvt_pk_bf16_f32 v86, v108, v109
    v_cvt_pk_bf16_f32 v87, v110, v111
    v_cvt_pk_bf16_f32 v88, v112, v113
    v_cvt_pk_bf16_f32 v89, v114, v115
    v_cvt_pk_bf16_f32 v90, v116, v117
    v_cvt_pk_bf16_f32 v91, v118, v119
    v_cvt_pk_bf16_f32 v92, v120, v121
    v_cvt_pk_bf16_f32 v93, v122, v123
    v_cvt_pk_bf16_f32 v94, v124, v125
    v_cvt_pk_bf16_f32 v95, v126, v127
    v_mul_f32 v128, v58, v128
    v_mul_f32 v129, v58, v129
    v_mul_f32 v130, v58, v130
    v_mul_f32 v131, v58, v131
    v_mul_f32 v132, v58, v132
    v_mul_f32 v133, v58, v133
    v_mul_f32 v134, v58, v134
    v_mul_f32 v135, v58, v135
    v_mul_f32 v136, v58, v136
    v_mul_f32 v137, v58, v137
    v_mul_f32 v138, v58, v138
    v_mul_f32 v139, v58, v139
    v_mul_f32 v140, v58, v140
    v_mul_f32 v141, v58, v141
    v_mul_f32 v142, v58, v142
    v_mul_f32 v143, v58, v143
    v_mul_f32 v144, v58, v144
    v_mul_f32 v145, v58, v145
    v_mul_f32 v146, v58, v146
    v_mul_f32 v147, v58, v147
    v_mul_f32 v148, v58, v148
    v_mul_f32 v149, v58, v149
    v_mul_f32 v150, v58, v150
    v_mul_f32 v151, v58, v151
    v_mul_f32 v152, v58, v152
    v_mul_f32 v153, v58, v153
    v_mul_f32 v154, v58, v154
    v_mul_f32 v155, v58, v155
    v_mul_f32 v156, v58, v156
    v_mul_f32 v157, v58, v157
    v_mul_f32 v158, v58, v158
    v_mul_f32 v159, v58, v159
    v_mul_f32 v160, v58, v160
    v_mul_f32 v161, v58, v161
    v_mul_f32 v162, v58, v162
    v_mul_f32 v163, v58, v163
    v_mul_f32 v164, v58, v164
    v_mul_f32 v165, v58, v165
    v_mul_f32 v166, v58, v166
    v_mul_f32 v167, v58, v167
    v_mul_f32 v168, v58, v168
    v_mul_f32 v169, v58, v169
    v_mul_f32 v170, v58, v170
    v_mul_f32 v171, v58, v171
    v_mul_f32 v172, v58, v172
    v_mul_f32 v173, v58, v173
    v_mul_f32 v174, v58, v174
    v_mul_f32 v175, v58, v175
    v_mul_f32 v176, v58, v176
    v_mul_f32 v177, v58, v177
    v_mul_f32 v178, v58, v178
    v_mul_f32 v179, v58, v179
    v_mul_f32 v180, v58, v180
    v_mul_f32 v181, v58, v181
    v_mul_f32 v182, v58, v182
    v_mul_f32 v183, v58, v183
    v_mul_f32 v184, v58, v184
    v_mul_f32 v185, v58, v185
    v_mul_f32 v186, v58, v186
    v_mul_f32 v187, v58, v187
    v_mul_f32 v188, v58, v188
    v_mul_f32 v189, v58, v189
    v_mul_f32 v190, v58, v190
    v_mul_f32 v191, v58, v191
    v_mul_f32 v192, v58, v192
    v_mul_f32 v193, v58, v193
    v_mul_f32 v194, v58, v194
    v_mul_f32 v195, v58, v195
    v_mul_f32 v196, v58, v196
    v_mul_f32 v197, v58, v197
    v_mul_f32 v198, v58, v198
    v_mul_f32 v199, v58, v199
    v_mul_f32 v200, v58, v200
    v_mul_f32 v201, v58, v201
    v_mul_f32 v202, v58, v202
    v_mul_f32 v203, v58, v203
    v_mul_f32 v204, v58, v204
    v_mul_f32 v205, v58, v205
    v_mul_f32 v206, v58, v206
    v_mul_f32 v207, v58, v207
    v_mul_f32 v208, v58, v208
    v_mul_f32 v209, v58, v209
    v_mul_f32 v210, v58, v210
    v_mul_f32 v211, v58, v211
    v_mul_f32 v212, v58, v212
    v_mul_f32 v213, v58, v213
    v_mul_f32 v214, v58, v214
    v_mul_f32 v215, v58, v215
    v_mul_f32 v216, v58, v216
    v_mul_f32 v217, v58, v217
    v_mul_f32 v218, v58, v218
    v_mul_f32 v219, v58, v219
    v_mul_f32 v220, v58, v220
    v_mul_f32 v221, v58, v221
    v_mul_f32 v222, v58, v222
    v_mul_f32 v223, v58, v223
    v_mul_f32 v224, v58, v224
    v_mul_f32 v225, v58, v225
    v_mul_f32 v226, v58, v226
    v_mul_f32 v227, v58, v227
    v_mul_f32 v228, v58, v228
    v_mul_f32 v229, v58, v229
    v_mul_f32 v230, v58, v230
    v_mul_f32 v231, v58, v231
    v_mul_f32 v232, v58, v232
    v_mul_f32 v233, v58, v233
    v_mul_f32 v234, v58, v234
    v_mul_f32 v235, v58, v235
    v_mul_f32 v236, v58, v236
    v_mul_f32 v237, v58, v237
    v_mul_f32 v238, v58, v238
    v_mul_f32 v239, v58, v239
    v_mul_f32 v240, v58, v240
    v_mul_f32 v241, v58, v241
    v_mul_f32 v242, v58, v242
    v_mul_f32 v243, v58, v243
    v_mul_f32 v244, v58, v244
    v_mul_f32 v245, v58, v245
    v_mul_f32 v246, v58, v246
    v_mul_f32 v247, v58, v247
    v_mul_f32 v248, v58, v248
    v_mul_f32 v249, v58, v249
    v_mul_f32 v250, v58, v250
    v_mul_f32 v251, v58, v251
    v_mul_f32 v252, v58, v252
    v_mul_f32 v253, v58, v253
    v_mul_f32 v254, v58, v254
    v_mul_f32 v255, v58, v255
    v_add_u32 v38, s68, v30
    v_add_u32 v39, s68, v31
    v_add_u32 v40, s68, v32
    v_add_u32 v41, s68, v33
    s_add_u32 s63, s64, s32
    s_waitcnt vmcnt(24)
    s_barrier
    ds_read_b64_tr_b16 a[64:65], v38 offset:0
    ds_read_b64_tr_b16 a[66:67], v38 offset:4096
    ds_read_b64_tr_b16 a[68:69], v39 offset:0
    ds_read_b64_tr_b16 a[70:71], v39 offset:4096
    ds_read_b64_tr_b16 a[72:73], v40 offset:0
    ds_read_b64_tr_b16 a[74:75], v40 offset:4096
    ds_read_b64_tr_b16 a[76:77], v41 offset:0
    ds_read_b64_tr_b16 a[78:79], v41 offset:4096
    ds_read_b64_tr_b16 a[80:81], v38 offset:256
    ds_read_b64_tr_b16 a[82:83], v38 offset:4352
    ds_read_b64_tr_b16 a[84:85], v39 offset:256
    ds_read_b64_tr_b16 a[86:87], v39 offset:4352
    s_waitcnt lgkmcnt(10)
    v_mfma_f32_32x32x16_bf16 v[128:143], a[64:67], v[80:83], v[128:143]
    ds_read_b64_tr_b16 a[88:89], v40 offset:256
    ds_read_b64_tr_b16 a[90:91], v40 offset:4352
    s_waitcnt lgkmcnt(10)
    v_mfma_f32_32x32x16_bf16 v[144:159], a[68:71], v[80:83], v[144:159]
    ds_read_b64_tr_b16 a[92:93], v41 offset:256
    ds_read_b64_tr_b16 a[94:95], v41 offset:4352
    s_waitcnt lgkmcnt(10)
    v_mfma_f32_32x32x16_bf16 v[160:175], a[72:75], v[80:83], v[160:175]
    ds_read_b64_tr_b16 a[96:97], v38 offset:8192
    ds_read_b64_tr_b16 a[98:99], v38 offset:12288
    s_waitcnt lgkmcnt(10)
    v_mfma_f32_32x32x16_bf16 v[176:191], a[76:79], v[80:83], v[176:191]
    ds_read_b64_tr_b16 a[100:101], v39 offset:8192
    ds_read_b64_tr_b16 a[102:103], v39 offset:12288
    s_waitcnt lgkmcnt(10)
    v_mfma_f32_32x32x16_bf16 v[192:207], a[80:83], v[80:83], v[192:207]
    ds_read_b64_tr_b16 a[104:105], v40 offset:8192
    ds_read_b64_tr_b16 a[106:107], v40 offset:12288
    s_waitcnt lgkmcnt(10)
    v_mfma_f32_32x32x16_bf16 v[208:223], a[84:87], v[80:83], v[208:223]
    ds_read_b64_tr_b16 a[108:109], v41 offset:8192
    ds_read_b64_tr_b16 a[110:111], v41 offset:12288
    s_waitcnt lgkmcnt(10)
    v_mfma_f32_32x32x16_bf16 v[224:239], a[88:91], v[80:83], v[224:239]
    ds_read_b64_tr_b16 a[112:113], v38 offset:8448
    ds_read_b64_tr_b16 a[114:115], v38 offset:12544
    s_waitcnt lgkmcnt(10)
    v_mfma_f32_32x32x16_bf16 v[240:255], a[92:95], v[80:83], v[240:255]
    ds_read_b64_tr_b16 a[116:117], v39 offset:8448
    ds_read_b64_tr_b16 a[118:119], v39 offset:12544
    s_waitcnt lgkmcnt(10)
    v_mfma_f32_32x32x16_bf16 v[128:143], a[96:99], v[84:87], v[128:143]
    ds_read_b64_tr_b16 a[120:121], v40 offset:8448
    ds_read_b64_tr_b16 a[122:123], v40 offset:12544
    s_waitcnt lgkmcnt(10)
    v_mfma_f32_32x32x16_bf16 v[144:159], a[100:103], v[84:87], v[144:159]
    ds_read_b64_tr_b16 a[124:125], v41 offset:8448
    ds_read_b64_tr_b16 a[126:127], v41 offset:12544
    s_waitcnt lgkmcnt(10)
    v_mfma_f32_32x32x16_bf16 v[160:175], a[104:107], v[84:87], v[160:175]
    ds_read_b64_tr_b16 a[64:65], v38 offset:16384
    ds_read_b64_tr_b16 a[66:67], v38 offset:20480
    s_waitcnt lgkmcnt(10)
    v_mfma_f32_32x32x16_bf16 v[176:191], a[108:111], v[84:87], v[176:191]
    ds_read_b64_tr_b16 a[68:69], v39 offset:16384
    ds_read_b64_tr_b16 a[70:71], v39 offset:20480
    s_waitcnt lgkmcnt(10)
    v_mfma_f32_32x32x16_bf16 v[192:207], a[112:115], v[84:87], v[192:207]
    ds_read_b64_tr_b16 a[72:73], v40 offset:16384
    ds_read_b64_tr_b16 a[74:75], v40 offset:20480
    s_waitcnt lgkmcnt(10)
    v_mfma_f32_32x32x16_bf16 v[208:223], a[116:119], v[84:87], v[208:223]
    ds_read_b64_tr_b16 a[76:77], v41 offset:16384
    ds_read_b64_tr_b16 a[78:79], v41 offset:20480
    s_waitcnt lgkmcnt(10)
    v_mfma_f32_32x32x16_bf16 v[224:239], a[120:123], v[84:87], v[224:239]
    ds_read_b64_tr_b16 a[80:81], v38 offset:16640
    ds_read_b64_tr_b16 a[82:83], v38 offset:20736
    s_waitcnt lgkmcnt(10)
    v_mfma_f32_32x32x16_bf16 v[240:255], a[124:127], v[84:87], v[240:255]
    ds_read_b64_tr_b16 a[84:85], v39 offset:16640
    ds_read_b64_tr_b16 a[86:87], v39 offset:20736
    s_waitcnt lgkmcnt(10)
    v_mfma_f32_32x32x16_bf16 v[128:143], a[64:67], v[88:91], v[128:143]
    ds_read_b64_tr_b16 a[88:89], v40 offset:16640
    ds_read_b64_tr_b16 a[90:91], v40 offset:20736
    s_waitcnt lgkmcnt(10)
    v_mfma_f32_32x32x16_bf16 v[144:159], a[68:71], v[88:91], v[144:159]
    ds_read_b64_tr_b16 a[92:93], v41 offset:16640
    ds_read_b64_tr_b16 a[94:95], v41 offset:20736
    s_waitcnt lgkmcnt(10)
    v_mfma_f32_32x32x16_bf16 v[160:175], a[72:75], v[88:91], v[160:175]
    ds_read_b64_tr_b16 a[96:97], v38 offset:24576
    ds_read_b64_tr_b16 a[98:99], v38 offset:28672
    s_waitcnt lgkmcnt(10)
    v_mfma_f32_32x32x16_bf16 v[176:191], a[76:79], v[88:91], v[176:191]
    ds_read_b64_tr_b16 a[100:101], v39 offset:24576
    ds_read_b64_tr_b16 a[102:103], v39 offset:28672
    s_waitcnt lgkmcnt(10)
    v_mfma_f32_32x32x16_bf16 v[192:207], a[80:83], v[88:91], v[192:207]
    ds_read_b64_tr_b16 a[104:105], v40 offset:24576
    ds_read_b64_tr_b16 a[106:107], v40 offset:28672
    s_waitcnt lgkmcnt(10)
    v_mfma_f32_32x32x16_bf16 v[208:223], a[84:87], v[88:91], v[208:223]
    ds_read_b64_tr_b16 a[108:109], v41 offset:24576
    ds_read_b64_tr_b16 a[110:111], v41 offset:28672
    s_waitcnt lgkmcnt(10)
    v_mfma_f32_32x32x16_bf16 v[224:239], a[88:91], v[88:91], v[224:239]
    ds_read_b64_tr_b16 a[112:113], v38 offset:24832
    ds_read_b64_tr_b16 a[114:115], v38 offset:28928
    s_waitcnt lgkmcnt(10)
    v_mfma_f32_32x32x16_bf16 v[240:255], a[92:95], v[88:91], v[240:255]
    ds_read_b64_tr_b16 a[116:117], v39 offset:24832
    ds_read_b64_tr_b16 a[118:119], v39 offset:28928
    s_waitcnt lgkmcnt(10)
    v_mfma_f32_32x32x16_bf16 v[128:143], a[96:99], v[92:95], v[128:143]
    ds_read_b64_tr_b16 a[120:121], v40 offset:24832
    ds_read_b64_tr_b16 a[122:123], v40 offset:28928
    s_waitcnt lgkmcnt(10)
    v_mfma_f32_32x32x16_bf16 v[144:159], a[100:103], v[92:95], v[144:159]
    ds_read_b64_tr_b16 a[124:125], v41 offset:24832
    ds_read_b64_tr_b16 a[126:127], v41 offset:28928
    s_waitcnt lgkmcnt(10)
    v_mfma_f32_32x32x16_bf16 v[160:175], a[104:107], v[92:95], v[160:175]
    s_waitcnt lgkmcnt(8)
    v_mfma_f32_32x32x16_bf16 v[176:191], a[108:111], v[92:95], v[176:191]
    s_waitcnt lgkmcnt(6)
    v_mfma_f32_32x32x16_bf16 v[192:207], a[112:115], v[92:95], v[192:207]
    s_waitcnt lgkmcnt(4)
    v_mfma_f32_32x32x16_bf16 v[208:223], a[116:119], v[92:95], v[208:223]
    s_waitcnt lgkmcnt(2)
    v_mfma_f32_32x32x16_bf16 v[224:239], a[120:123], v[92:95], v[224:239]
    s_waitcnt lgkmcnt(0)
    v_mfma_f32_32x32x16_bf16 v[240:255], a[124:127], v[92:95], v[240:255]
    v_mov_b32 v61, v57
    s_nop 1
    v_permlane32_swap_b32 v57, v61
    v_add_f32 v57, v57, v61
    v_rcp_f32 v57, v57
    s_nop 7
    s_nop 7
    v_mul_f32 v128, v57, v128
    v_mul_f32 v129, v57, v129
    v_mul_f32 v130, v57, v130
    v_mul_f32 v131, v57, v131
    v_mul_f32 v132, v57, v132
    v_mul_f32 v133, v57, v133
    v_mul_f32 v134, v57, v134
    v_mul_f32 v135, v57, v135
    v_mul_f32 v136, v57, v136
    v_mul_f32 v137, v57, v137
    v_mul_f32 v138, v57, v138
    v_mul_f32 v139, v57, v139
    v_mul_f32 v140, v57, v140
    v_mul_f32 v141, v57, v141
    v_mul_f32 v142, v57, v142
    v_mul_f32 v143, v57, v143
    v_mul_f32 v144, v57, v144
    v_mul_f32 v145, v57, v145
    v_mul_f32 v146, v57, v146
    v_mul_f32 v147, v57, v147
    v_mul_f32 v148, v57, v148
    v_mul_f32 v149, v57, v149
    v_mul_f32 v150, v57, v150
    v_mul_f32 v151, v57, v151
    v_mul_f32 v152, v57, v152
    v_mul_f32 v153, v57, v153
    v_mul_f32 v154, v57, v154
    v_mul_f32 v155, v57, v155
    v_mul_f32 v156, v57, v156
    v_mul_f32 v157, v57, v157
    v_mul_f32 v158, v57, v158
    v_mul_f32 v159, v57, v159
    v_mul_f32 v160, v57, v160
    v_mul_f32 v161, v57, v161
    v_mul_f32 v162, v57, v162
    v_mul_f32 v163, v57, v163
    v_mul_f32 v164, v57, v164
    v_mul_f32 v165, v57, v165
    v_mul_f32 v166, v57, v166
    v_mul_f32 v167, v57, v167
    v_mul_f32 v168, v57, v168
    v_mul_f32 v169, v57, v169
    v_mul_f32 v170, v57, v170
    v_mul_f32 v171, v57, v171
    v_mul_f32 v172, v57, v172
    v_mul_f32 v173, v57, v173
    v_mul_f32 v174, v57, v174
    v_mul_f32 v175, v57, v175
    v_mul_f32 v176, v57, v176
    v_mul_f32 v177, v57, v177
    v_mul_f32 v178, v57, v178
    v_mul_f32 v179, v57, v179
    v_mul_f32 v180, v57, v180
    v_mul_f32 v181, v57, v181
    v_mul_f32 v182, v57, v182
    v_mul_f32 v183, v57, v183
    v_mul_f32 v184, v57, v184
    v_mul_f32 v185, v57, v185
    v_mul_f32 v186, v57, v186
    v_mul_f32 v187, v57, v187
    v_mul_f32 v188, v57, v188
    v_mul_f32 v189, v57, v189
    v_mul_f32 v190, v57, v190
    v_mul_f32 v191, v57, v191
    v_mul_f32 v192, v57, v192
    v_mul_f32 v193, v57, v193
    v_mul_f32 v194, v57, v194
    v_mul_f32 v195, v57, v195
    v_mul_f32 v196, v57, v196
    v_mul_f32 v197, v57, v197
    v_mul_f32 v198, v57, v198
    v_mul_f32 v199, v57, v199
    v_mul_f32 v200, v57, v200
    v_mul_f32 v201, v57, v201
    v_mul_f32 v202, v57, v202
    v_mul_f32 v203, v57, v203
    v_mul_f32 v204, v57, v204
    v_mul_f32 v205, v57, v205
    v_mul_f32 v206, v57, v206
    v_mul_f32 v207, v57, v207
    v_mul_f32 v208, v57, v208
    v_mul_f32 v209, v57, v209
    v_mul_f32 v210, v57, v210
    v_mul_f32 v211, v57, v211
    v_mul_f32 v212, v57, v212
    v_mul_f32 v213, v57, v213
    v_mul_f32 v214, v57, v214
    v_mul_f32 v215, v57, v215
    v_mul_f32 v216, v57, v216
    v_mul_f32 v217, v57, v217
    v_mul_f32 v218, v57, v218
    v_mul_f32 v219, v57, v219
    v_mul_f32 v220, v57, v220
    v_mul_f32 v221, v57, v221
    v_mul_f32 v222, v57, v222
    v_mul_f32 v223, v57, v223
    v_mul_f32 v224, v57, v224
    v_mul_f32 v225, v57, v225
    v_mul_f32 v226, v57, v226
    v_mul_f32 v227, v57, v227
    v_mul_f32 v228, v57, v228
    v_mul_f32 v229, v57, v229
    v_mul_f32 v230, v57, v230
    v_mul_f32 v231, v57, v231
    v_mul_f32 v232, v57, v232
    v_mul_f32 v233, v57, v233
    v_mul_f32 v234, v57, v234
    v_mul_f32 v235, v57, v235
    v_mul_f32 v236, v57, v236
    v_mul_f32 v237, v57, v237
    v_mul_f32 v238, v57, v238
    v_mul_f32 v239, v57, v239
    v_mul_f32 v240, v57, v240
    v_mul_f32 v241, v57, v241
    v_mul_f32 v242, v57, v242
    v_mul_f32 v243, v57, v243
    v_mul_f32 v244, v57, v244
    v_mul_f32 v245, v57, v245
    v_mul_f32 v246, v57, v246
    v_mul_f32 v247, v57, v247
    v_mul_f32 v248, v57, v248
    v_mul_f32 v249, v57, v249
    v_mul_f32 v250, v57, v250
    v_mul_f32 v251, v57, v251
    v_mul_f32 v252, v57, v252
    v_mul_f32 v253, v57, v253
    v_mul_f32 v254, v57, v254
    v_mul_f32 v255, v57, v255
    v_cvt_pk_bf16_f32 v128, v128, v129
    v_cvt_pk_bf16_f32 v129, v130, v131
    v_cvt_pk_bf16_f32 v130, v132, v133
    v_cvt_pk_bf16_f32 v131, v134, v135
    v_cvt_pk_bf16_f32 v132, v136, v137
    v_cvt_pk_bf16_f32 v133, v138, v139
    v_cvt_pk_bf16_f32 v134, v140, v141
    v_cvt_pk_bf16_f32 v135, v142, v143
    v_cvt_pk_bf16_f32 v136, v144, v145
    v_cvt_pk_bf16_f32 v137, v146, v147
    v_cvt_pk_bf16_f32 v138, v148, v149
    v_cvt_pk_bf16_f32 v139, v150, v151
    v_cvt_pk_bf16_f32 v140, v152, v153
    v_cvt_pk_bf16_f32 v141, v154, v155
    v_cvt_pk_bf16_f32 v142, v156, v157
    v_cvt_pk_bf16_f32 v143, v158, v159
    v_cvt_pk_bf16_f32 v144, v160, v161
    v_cvt_pk_bf16_f32 v145, v162, v163
    v_cvt_pk_bf16_f32 v146, v164, v165
    v_cvt_pk_bf16_f32 v147, v166, v167
    v_cvt_pk_bf16_f32 v148, v168, v169
    v_cvt_pk_bf16_f32 v149, v170, v171
    v_cvt_pk_bf16_f32 v150, v172, v173
    v_cvt_pk_bf16_f32 v151, v174, v175
    v_cvt_pk_bf16_f32 v152, v176, v177
    v_cvt_pk_bf16_f32 v153, v178, v179
    v_cvt_pk_bf16_f32 v154, v180, v181
    v_cvt_pk_bf16_f32 v155, v182, v183
    v_cvt_pk_bf16_f32 v156, v184, v185
    v_cvt_pk_bf16_f32 v157, v186, v187
    v_cvt_pk_bf16_f32 v158, v188, v189
    v_cvt_pk_bf16_f32 v159, v190, v191
    v_cvt_pk_bf16_f32 v160, v192, v193
    v_cvt_pk_bf16_f32 v161, v194, v195
    v_cvt_pk_bf16_f32 v162, v196, v197
    v_cvt_pk_bf16_f32 v163, v198, v199
    v_cvt_pk_bf16_f32 v164, v200, v201
    v_cvt_pk_bf16_f32 v165, v202, v203
    v_cvt_pk_bf16_f32 v166, v204, v205
    v_cvt_pk_bf16_f32 v167, v206, v207
    v_cvt_pk_bf16_f32 v168, v208, v209
    v_cvt_pk_bf16_f32 v169, v210, v211
    v_cvt_pk_bf16_f32 v170, v212, v213
    v_cvt_pk_bf16_f32 v171, v214, v215
    v_cvt_pk_bf16_f32 v172, v216, v217
    v_cvt_pk_bf16_f32 v173, v218, v219
    v_cvt_pk_bf16_f32 v174, v220, v221
    v_cvt_pk_bf16_f32 v175, v222, v223
    v_cvt_pk_bf16_f32 v176, v224, v225
    v_cvt_pk_bf16_f32 v177, v226, v227
    v_cvt_pk_bf16_f32 v178, v228, v229
    v_cvt_pk_bf16_f32 v179, v230, v231
    v_cvt_pk_bf16_f32 v180, v232, v233
    v_cvt_pk_bf16_f32 v181, v234, v235
    v_cvt_pk_bf16_f32 v182, v236, v237
    v_cvt_pk_bf16_f32 v183, v238, v239
    v_cvt_pk_bf16_f32 v184, v240, v241
    v_cvt_pk_bf16_f32 v185, v242, v243
    v_cvt_pk_bf16_f32 v186, v244, v245
    v_cvt_pk_bf16_f32 v187, v246, v247
    v_cvt_pk_bf16_f32 v188, v248, v249
    v_cvt_pk_bf16_f32 v189, v250, v251
    v_cvt_pk_bf16_f32 v190, v252, v253
    v_cvt_pk_bf16_f32 v191, v254, v255
    s_lshl_b32 s60, s65, 10
    s_lshl_b32 s61, s66, 15
    s_add_u32 s61, s61, s60
    v_lshlrev_b32 v1, 4, v0
    v_add_u32 v2, s61, v1
    v_add_u32 v3, s60, v1
    s_barrier
    ds_write_b128 v2, v[128:131] offset:0
    ds_write_b128 v2, v[132:135] offset:2048
    ds_write_b128 v2, v[136:139] offset:4096
    ds_write_b128 v2, v[140:143] offset:6144
    ds_write_b128 v2, v[144:147] offset:8192
    ds_write_b128 v2, v[148:151] offset:10240
    ds_write_b128 v2, v[152:155] offset:12288
    ds_write_b128 v2, v[156:159] offset:14336
    ds_write_b128 v2, v[160:163] offset:16384
    ds_write_b128 v2, v[164:167] offset:18432
    ds_write_b128 v2, v[168:171] offset:20480
    ds_write_b128 v2, v[172:175] offset:22528
    ds_write_b128 v2, v[176:179] offset:24576
    ds_write_b128 v2, v[180:183] offset:26624
    ds_write_b128 v2, v[184:187] offset:28672
    ds_write_b128 v2, v[188:191] offset:30720
    s_waitcnt lgkmcnt(0)
    s_barrier
    s_lshl_b32 s60, s75, 13
    s_add_u32 s61, s60, 0x0
    s_and_b32 s61, s61, 0xffff
    v_add_u32 v4, s61, v3
    ds_read_b128 a[128:131], v4 offset:0
    ds_read_b128 a[132:135], v4 offset:2048
    ds_read_b128 a[136:139], v4 offset:4096
    ds_read_b128 a[140:143], v4 offset:6144
    s_add_u32 s61, s60, 0x2000
    s_and_b32 s61, s61, 0xffff
    v_add_u32 v4, s61, v3
    ds_read_b128 a[144:147], v4 offset:0
    ds_read_b128 a[148:151], v4 offset:2048
    ds_read_b128 a[152:155], v4 offset:4096
    ds_read_b128 a[156:159], v4 offset:6144
    s_waitcnt lgkmcnt(0)
    s_add_u32 s61, s60, 0x4000
    s_and_b32 s61, s61, 0xffff
    v_add_u32 v4, s61, v3
    ds_read_b128 a[160:163], v4 offset:0
    ds_read_b128 a[164:167], v4 offset:2048
    ds_read_b128 a[168:171], v4 offset:4096
    ds_read_b128 a[172:175], v4 offset:6144
    s_add_u32 s61, s60, 0x6000
    s_and_b32 s61, s61, 0xffff
    v_add_u32 v4, s61, v3
    ds_read_b128 a[176:179], v4 offset:0
    ds_read_b128 a[180:183], v4 offset:2048
    ds_read_b128 a[184:187], v4 offset:4096
    ds_read_b128 a[188:191], v4 offset:6144
    s_waitcnt lgkmcnt(0)
    s_add_u32 s61, s60, 0x8000
    s_and_b32 s61, s61, 0xffff
    v_add_u32 v4, s61, v3
    ds_read_b128 a[192:195], v4 offset:0
    ds_read_b128 a[196:199], v4 offset:2048
    ds_read_b128 a[200:203], v4 offset:4096
    ds_read_b128 a[204:207], v4 offset:6144
    s_add_u32 s61, s60, 0xa000
    s_and_b32 s61, s61, 0xffff
    v_add_u32 v4, s61, v3
    ds_read_b128 a[208:211], v4 offset:0
    ds_read_b128 a[212:215], v4 offset:2048
    ds_read_b128 a[216:219], v4 offset:4096
    ds_read_b128 a[220:223], v4 offset:6144
    s_waitcnt lgkmcnt(0)
    s_add_u32 s61, s60, 0xc000
    s_and_b32 s61, s61, 0xffff
    v_add_u32 v4, s61, v3
    ds_read_b128 a[224:227], v4 offset:0
    ds_read_b128 a[228:231], v4 offset:2048
    ds_read_b128 a[232:235], v4 offset:4096
    ds_read_b128 a[236:239], v4 offset:6144
    s_add_u32 s61, s60, 0xe000
    s_and_b32 s61, s61, 0xffff
    v_add_u32 v4, s61, v3
    ds_read_b128 a[240:243], v4 offset:0
    ds_read_b128 a[244:247], v4 offset:2048
    ds_read_b128 a[248:251], v4 offset:4096
    ds_read_b128 a[252:255], v4 offset:6144
    s_waitcnt lgkmcnt(0)
    s_mul_i32 s83, s5, 57344
    s_mul_i32 s61, s3, 14336
    s_add_u32 s83, s83, s61
    v_lshlrev_b32 v1, 4, v0
    s_waitcnt lgkmcnt(0)
    s_waitcnt vmcnt(16)
    s_barrier
    v_add_u32 v38, 0x10000, v46
    v_add_u32 v39, 0x10000, v47
    v_add_u32 v40, 0x10000, v48
    v_add_u32 v41, 0x10000, v49
    v_add_u32 v42, 0x10000, v50
    v_add_u32 v43, 0x10000, v51
    v_add_u32 v44, 0x10000, v52
    ds_read_b64_tr_b16 a[64:65], v38 offset:0
    ds_read_b64_tr_b16 a[66:67], v38 offset:8192
    ds_read_b64_tr_b16 a[68:69], v39 offset:0
    ds_read_b64_tr_b16 a[70:71], v39 offset:8192
    ds_read_b64_tr_b16 a[72:73], v40 offset:0
    ds_read_b64_tr_b16 a[74:75], v40 offset:8192
    ds_read_b64_tr_b16 a[76:77], v41 offset:0
    ds_read_b64_tr_b16 a[78:79], v41 offset:8192
    ds_read_b64_tr_b16 a[80:81], v42 offset:0
    ds_read_b64_tr_b16 a[82:83], v42 offset:8192
    ds_read_b64_tr_b16 a[84:85], v43 offset:0
    ds_read_b64_tr_b16 a[86:87], v43 offset:8192
    s_waitcnt lgkmcnt(10)
    v_mfma_f32_32x32x16_bf16 v[128:143], a[64:67], a[128:131], 0
    ds_read_b64_tr_b16 a[88:89], v44 offset:0
    ds_read_b64_tr_b16 a[90:91], v44 offset:8192
    s_add_u32 m0, s32, 0x0
    s_nop 0
    buffer_load_dwordx4 v8, s[24:27], s59 offen offset:0 lds
    s_waitcnt lgkmcnt(10)
    v_mfma_f32_32x32x16_bf16 v[144:159], a[68:71], a[128:131], 0
    ds_read_b64_tr_b16 a[92:93], v38 offset:16384
    ds_read_b64_tr_b16 a[94:95], v38 offset:24576
    buffer_load_dwordx4 v9, s[24:27], s59 offen offset:1024 lds
    s_waitcnt lgkmcnt(10)
    v_mfma_f32_32x32x16_bf16 v[160:175], a[72:75], a[128:131], 0
    ds_read_b64_tr_b16 a[96:97], v39 offset:16384
    ds_read_b64_tr_b16 a[98:99], v39 offset:24576
    buffer_load_dwordx4 v10, s[24:27], s59 offen offset:2048 lds
    s_waitcnt lgkmcnt(10)
    v_mfma_f32_32x32x16_bf16 v[176:191], a[76:79], a[128:131], 0
    ds_read_b64_tr_b16 a[100:101], v40 offset:16384
    ds_read_b64_tr_b16 a[102:103], v40 offset:24576
    buffer_load_dwordx4 v11, s[24:27], s59 offen offset:3072 lds
    s_waitcnt lgkmcnt(10)
    v_mfma_f32_32x32x16_bf16 v[192:207], a[80:83], a[128:131], 0
    ds_read_b64_tr_b16 a[104:105], v41 offset:16384
    ds_read_b64_tr_b16 a[106:107], v41 offset:24576
    s_add_u32 m0, s32, 0x1000
    s_nop 0
    buffer_load_dwordx4 v68, s[24:27], s59 offen offset:0 lds
    s_waitcnt lgkmcnt(10)
    v_mfma_f32_32x32x16_bf16 v[208:223], a[84:87], a[128:131], 0
    ds_read_b64_tr_b16 a[108:109], v42 offset:16384
    ds_read_b64_tr_b16 a[110:111], v42 offset:24576
    buffer_load_dwordx4 v69, s[24:27], s59 offen offset:1024 lds
    s_waitcnt lgkmcnt(10)
    v_mfma_f32_32x32x16_bf16 v[224:239], a[88:91], a[128:131], 0
    ds_read_b64_tr_b16 a[112:113], v43 offset:16384
    ds_read_b64_tr_b16 a[114:115], v43 offset:24576
    buffer_load_dwordx4 v70, s[24:27], s59 offen offset:2048 lds
    s_waitcnt lgkmcnt(10)
    v_mfma_f32_32x32x16_bf16 v[128:143], a[92:95], a[132:135], v[128:143]
    ds_read_b64_tr_b16 a[116:117], v44 offset:16384
    ds_read_b64_tr_b16 a[118:119], v44 offset:24576
    buffer_load_dwordx4 v71, s[24:27], s59 offen offset:3072 lds
    s_add_u32 s59, s59, 0x7000
    s_cmp_ge_u32 s59, s74
    s_cselect_b32 s60, 0x70000, 0
    s_sub_u32 s59, s59, s60
    s_waitcnt lgkmcnt(10)
    v_mfma_f32_32x32x16_bf16 v[144:159], a[96:99], a[132:135], v[144:159]
    s_add_u32 m0, s32, 0x8000
    s_nop 0
    buffer_load_dwordx4 v8, s[24:27], s59 offen offset:0 lds
    s_waitcnt lgkmcnt(8)
    v_mfma_f32_32x32x16_bf16 v[160:175], a[100:103], a[132:135], v[160:175]
    buffer_load_dwordx4 v9, s[24:27], s59 offen offset:1024 lds
    s_waitcnt lgkmcnt(6)
    v_mfma_f32_32x32x16_bf16 v[176:191], a[104:107], a[132:135], v[176:191]
    buffer_load_dwordx4 v10, s[24:27], s59 offen offset:2048 lds
    s_waitcnt lgkmcnt(4)
    v_mfma_f32_32x32x16_bf16 v[192:207], a[108:111], a[132:135], v[192:207]
    buffer_load_dwordx4 v11, s[24:27], s59 offen offset:3072 lds
    s_add_u32 m0, s32, 0x9000
    s_nop 0
    buffer_load_dwordx4 v68, s[24:27], s59 offen offset:0 lds
    buffer_load_dwordx4 v69, s[24:27], s59 offen offset:1024 lds
    buffer_load_dwordx4 v70, s[24:27], s59 offen offset:2048 lds
    buffer_load_dwordx4 v71, s[24:27], s59 offen offset:3072 lds
    s_add_u32 s59, s59, 0x7000
    s_cmp_ge_u32 s59, s74
    s_cselect_b32 s60, 0x70000, 0
    s_sub_u32 s59, s59, s60
    s_waitcnt lgkmcnt(0)
    s_waitcnt vmcnt(24)
    s_barrier
    v_add_u32 v96, 0x18000, v46
    v_add_u32 v97, 0x18000, v47
    v_add_u32 v98, 0x18000, v48
    v_add_u32 v99, 0x18000, v49
    v_add_u32 v100, 0x18000, v50
    v_add_u32 v101, 0x18000, v51
    v_add_u32 v102, 0x18000, v52
    ds_read_b64_tr_b16 a[120:121], v96 offset:0
    ds_read_b64_tr_b16 a[122:123], v96 offset:8192
    ds_read_b64_tr_b16 a[124:125], v97 offset:0
    ds_read_b64_tr_b16 a[126:127], v97 offset:8192
    ds_read_b64_tr_b16 a[64:65], v98 offset:0
    ds_read_b64_tr_b16 a[66:67], v98 offset:8192
    ds_read_b64_tr_b16 a[68:69], v99 offset:0
    ds_read_b64_tr_b16 a[70:71], v99 offset:8192
    s_add_u32 m0, s32, 0x10000
    s_nop 0
    buffer_load_dwordx4 v8, s[24:27], s59 offen offset:0 lds
    s_waitcnt lgkmcnt(10)
    v_mfma_f32_32x32x16_bf16 v[208:223], a[112:115], a[132:135], v[208:223]
    ds_read_b64_tr_b16 a[72:73], v100 offset:0
    ds_read_b64_tr_b16 a[74:75], v100 offset:8192
    buffer_load_dwordx4 v9, s[24:27], s59 offen offset:1024 lds
    s_waitcnt lgkmcnt(10)
    v_mfma_f32_32x32x16_bf16 v[224:239], a[116:119], a[132:135], v[224:239]
    ds_read_b64_tr_b16 a[76:77], v101 offset:0
    ds_read_b64_tr_b16 a[78:79], v101 offset:8192
    buffer_load_dwordx4 v10, s[24:27], s59 offen offset:2048 lds
    s_waitcnt lgkmcnt(10)
    v_mfma_f32_32x32x16_bf16 v[128:143], a[120:123], a[136:139], v[128:143]
    ds_read_b64_tr_b16 a[80:81], v102 offset:0
    ds_read_b64_tr_b16 a[82:83], v102 offset:8192
    buffer_load_dwordx4 v11, s[24:27], s59 offen offset:3072 lds
    s_waitcnt lgkmcnt(10)
    v_mfma_f32_32x32x16_bf16 v[144:159], a[124:127], a[136:139], v[144:159]
    ds_read_b64_tr_b16 a[84:85], v96 offset:16384
    ds_read_b64_tr_b16 a[86:87], v96 offset:24576
    s_add_u32 m0, s32, 0x11000
    s_nop 0
    buffer_load_dwordx4 v68, s[24:27], s59 offen offset:0 lds
    s_waitcnt lgkmcnt(10)
    v_mfma_f32_32x32x16_bf16 v[160:175], a[64:67], a[136:139], v[160:175]
    ds_read_b64_tr_b16 a[88:89], v97 offset:16384
    ds_read_b64_tr_b16 a[90:91], v97 offset:24576
    buffer_load_dwordx4 v69, s[24:27], s59 offen offset:1024 lds
    s_waitcnt lgkmcnt(10)
    v_mfma_f32_32x32x16_bf16 v[176:191], a[68:71], a[136:139], v[176:191]
    ds_read_b64_tr_b16 a[92:93], v98 offset:16384
    ds_read_b64_tr_b16 a[94:95], v98 offset:24576
    buffer_load_dwordx4 v70, s[24:27], s59 offen offset:2048 lds
    s_waitcnt lgkmcnt(10)
    v_mfma_f32_32x32x16_bf16 v[192:207], a[72:75], a[136:139], v[192:207]
    ds_read_b64_tr_b16 a[96:97], v99 offset:16384
    ds_read_b64_tr_b16 a[98:99], v99 offset:24576
    buffer_load_dwordx4 v71, s[24:27], s59 offen offset:3072 lds
    s_add_u32 s59, s59, 0x7000
    s_cmp_ge_u32 s59, s74
    s_cselect_b32 s60, 0x70000, 0
    s_sub_u32 s59, s59, s60
    s_waitcnt lgkmcnt(10)
    v_mfma_f32_32x32x16_bf16 v[208:223], a[76:79], a[136:139], v[208:223]
    ds_read_b64_tr_b16 a[100:101], v100 offset:16384
    ds_read_b64_tr_b16 a[102:103], v100 offset:24576
    s_waitcnt lgkmcnt(10)
    v_mfma_f32_32x32x16_bf16 v[224:239], a[80:83], a[136:139], v[224:239]
    ds_read_b64_tr_b16 a[104:105], v101 offset:16384
    ds_read_b64_tr_b16 a[106:107], v101 offset:24576
    s_waitcnt lgkmcnt(10)
    v_mfma_f32_32x32x16_bf16 v[128:143], a[84:87], a[140:143], v[128:143]
    ds_read_b64_tr_b16 a[108:109], v102 offset:16384
    ds_read_b64_tr_b16 a[110:111], v102 offset:24576
    s_waitcnt lgkmcnt(10)
    v_mfma_f32_32x32x16_bf16 v[144:159], a[88:91], a[140:143], v[144:159]
    s_waitcnt lgkmcnt(8)
    v_mfma_f32_32x32x16_bf16 v[160:175], a[92:95], a[140:143], v[160:175]
    s_waitcnt lgkmcnt(6)
    v_mfma_f32_32x32x16_bf16 v[176:191], a[96:99], a[140:143], v[176:191]
    s_waitcnt lgkmcnt(4)
    v_mfma_f32_32x32x16_bf16 v[192:207], a[100:103], a[140:143], v[192:207]
    s_waitcnt lgkmcnt(0)
    s_waitcnt vmcnt(24)
    s_barrier
    v_add_u32 v38, 0x20000, v46
    v_add_u32 v39, 0x20000, v47
    v_add_u32 v40, 0x20000, v48
    v_add_u32 v41, 0x20000, v49
    v_add_u32 v42, 0x20000, v50
    v_add_u32 v43, 0x20000, v51
    v_add_u32 v44, 0x20000, v52
    ds_read_b64_tr_b16 a[112:113], v38 offset:0
    ds_read_b64_tr_b16 a[114:115], v38 offset:8192
    ds_read_b64_tr_b16 a[116:117], v39 offset:0
    ds_read_b64_tr_b16 a[118:119], v39 offset:8192
    ds_read_b64_tr_b16 a[120:121], v40 offset:0
    ds_read_b64_tr_b16 a[122:123], v40 offset:8192
    ds_read_b64_tr_b16 a[124:125], v41 offset:0
    ds_read_b64_tr_b16 a[126:127], v41 offset:8192
    s_add_u32 m0, s32, 0x18000
    s_nop 0
    buffer_load_dwordx4 v8, s[24:27], s59 offen offset:0 lds
    s_waitcnt lgkmcnt(10)
    v_mfma_f32_32x32x16_bf16 v[208:223], a[104:107], a[140:143], v[208:223]
    ds_read_b64_tr_b16 a[64:65], v42 offset:0
    ds_read_b64_tr_b16 a[66:67], v42 offset:8192
    buffer_load_dwordx4 v9, s[24:27], s59 offen offset:1024 lds
    s_waitcnt lgkmcnt(10)
    v_mfma_f32_32x32x16_bf16 v[224:239], a[108:111], a[140:143], v[224:239]
    ds_read_b64_tr_b16 a[68:69], v43 offset:0
    ds_read_b64_tr_b16 a[70:71], v43 offset:8192
    buffer_load_dwordx4 v10, s[24:27], s59 offen offset:2048 lds
    s_waitcnt lgkmcnt(10)
    v_mfma_f32_32x32x16_bf16 v[128:143], a[112:115], a[144:147], v[128:143]
    ds_read_b64_tr_b16 a[72:73], v44 offset:0
    ds_read_b64_tr_b16 a[74:75], v44 offset:8192
    buffer_load_dwordx4 v11, s[24:27], s59 offen offset:3072 lds
    s_waitcnt lgkmcnt(10)
    v_mfma_f32_32x32x16_bf16 v[144:159], a[116:119], a[144:147], v[144:159]
    ds_read_b64_tr_b16 a[76:77], v38 offset:16384
    ds_read_b64_tr_b16 a[78:79], v38 offset:24576
    s_add_u32 m0, s32, 0x19000
    s_nop 0
    buffer_load_dwordx4 v68, s[24:27], s59 offen offset:0 lds
    s_waitcnt lgkmcnt(10)
    v_mfma_f32_32x32x16_bf16 v[160:175], a[120:123], a[144:147], v[160:175]
    ds_read_b64_tr_b16 a[80:81], v39 offset:16384
    ds_read_b64_tr_b16 a[82:83], v39 offset:24576
    buffer_load_dwordx4 v69, s[24:27], s59 offen offset:1024 lds
    s_waitcnt lgkmcnt(10)
    v_mfma_f32_32x32x16_bf16 v[176:191], a[124:127], a[144:147], v[176:191]
    ds_read_b64_tr_b16 a[84:85], v40 offset:16384
    ds_read_b64_tr_b16 a[86:87], v40 offset:24576
    buffer_load_dwordx4 v70, s[24:27], s59 offen offset:2048 lds
    s_waitcnt lgkmcnt(10)
    v_mfma_f32_32x32x16_bf16 v[192:207], a[64:67], a[144:147], v[192:207]
    ds_read_b64_tr_b16 a[88:89], v41 offset:16384
    ds_read_b64_tr_b16 a[90:91], v41 offset:24576
    buffer_load_dwordx4 v71, s[24:27], s59 offen offset:3072 lds
    s_add_u32 s59, s59, 0x7000
    s_cmp_ge_u32 s59, s74
    s_cselect_b32 s60, 0x70000, 0
    s_sub_u32 s59, s59, s60
    s_waitcnt lgkmcnt(10)
    v_mfma_f32_32x32x16_bf16 v[208:223], a[68:71], a[144:147], v[208:223]
    ds_read_b64_tr_b16 a[92:93], v42 offset:16384
    ds_read_b64_tr_b16 a[94:95], v42 offset:24576
    s_waitcnt lgkmcnt(10)
    v_mfma_f32_32x32x16_bf16 v[224:239], a[72:75], a[144:147], v[224:239]
    ds_read_b64_tr_b16 a[96:97], v43 offset:16384
    ds_read_b64_tr_b16 a[98:99], v43 offset:24576
    s_waitcnt lgkmcnt(10)
    v_mfma_f32_32x32x16_bf16 v[128:143], a[76:79], a[148:151], v[128:143]
    ds_read_b64_tr_b16 a[100:101], v44 offset:16384
    ds_read_b64_tr_b16 a[102:103], v44 offset:24576
    s_waitcnt lgkmcnt(10)
    v_mfma_f32_32x32x16_bf16 v[144:159], a[80:83], a[148:151], v[144:159]
    s_waitcnt lgkmcnt(8)
    v_mfma_f32_32x32x16_bf16 v[160:175], a[84:87], a[148:151], v[160:175]
    s_waitcnt lgkmcnt(6)
    v_mfma_f32_32x32x16_bf16 v[176:191], a[88:91], a[148:151], v[176:191]
    s_waitcnt lgkmcnt(4)
    v_mfma_f32_32x32x16_bf16 v[192:207], a[92:95], a[148:151], v[192:207]
    s_waitcnt lgkmcnt(0)
    s_waitcnt vmcnt(24)
    s_barrier
    v_add_u32 v96, 0x0, v46
    v_add_u32 v97, 0x0, v47
    v_add_u32 v98, 0x0, v48
    v_add_u32 v99, 0x0, v49
    v_add_u32 v100, 0x0, v50
    v_add_u32 v101, 0x0, v51
    v_add_u32 v102, 0x0, v52
    ds_read_b64_tr_b16 a[104:105], v96 offset:0
    ds_read_b64_tr_b16 a[106:107], v96 offset:8192
    ds_read_b64_tr_b16 a[108:109], v97 offset:0
    ds_read_b64_tr_b16 a[110:111], v97 offset:8192
    ds_read_b64_tr_b16 a[112:113], v98 offset:0
    ds_read_b64_tr_b16 a[114:115], v98 offset:8192
    ds_read_b64_tr_b16 a[116:117], v99 offset:0
    ds_read_b64_tr_b16 a[118:119], v99 offset:8192
    s_add_u32 m0, s32, 0x20000
    s_nop 0
    buffer_load_dwordx4 v8, s[24:27], s59 offen offset:0 lds
    s_waitcnt lgkmcnt(10)
    v_mfma_f32_32x32x16_bf16 v[208:223], a[96:99], a[148:151], v[208:223]
    ds_read_b64_tr_b16 a[120:121], v100 offset:0
    ds_read_b64_tr_b16 a[122:123], v100 offset:8192
    buffer_load_dwordx4 v9, s[24:27], s59 offen offset:1024 lds
    s_waitcnt lgkmcnt(10)
    v_mfma_f32_32x32x16_bf16 v[224:239], a[100:103], a[148:151], v[224:239]
    ds_read_b64_tr_b16 a[124:125], v101 offset:0
    ds_read_b64_tr_b16 a[126:127], v101 offset:8192
    buffer_load_dwordx4 v10, s[24:27], s59 offen offset:2048 lds
    s_waitcnt lgkmcnt(10)
    v_mfma_f32_32x32x16_bf16 v[128:143], a[104:107], a[152:155], v[128:143]
    ds_read_b64_tr_b16 a[64:65], v102 offset:0
    ds_read_b64_tr_b16 a[66:67], v102 offset:8192
    buffer_load_dwordx4 v11, s[24:27], s59 offen offset:3072 lds
    s_waitcnt lgkmcnt(10)
    v_mfma_f32_32x32x16_bf16 v[144:159], a[108:111], a[152:155], v[144:159]
    ds_read_b64_tr_b16 a[68:69], v96 offset:16384
    ds_read_b64_tr_b16 a[70:71], v96 offset:24576
    s_add_u32 m0, s32, 0x21000
    s_nop 0
    buffer_load_dwordx4 v68, s[24:27], s59 offen offset:0 lds
    s_waitcnt lgkmcnt(10)
    v_mfma_f32_32x32x16_bf16 v[160:175], a[112:115], a[152:155], v[160:175]
    ds_read_b64_tr_b16 a[72:73], v97 offset:16384
    ds_read_b64_tr_b16 a[74:75], v97 offset:24576
    buffer_load_dwordx4 v69, s[24:27], s59 offen offset:1024 lds
    s_waitcnt lgkmcnt(10)
    v_mfma_f32_32x32x16_bf16 v[176:191], a[116:119], a[152:155], v[176:191]
    ds_read_b64_tr_b16 a[76:77], v98 offset:16384
    ds_read_b64_tr_b16 a[78:79], v98 offset:24576
    buffer_load_dwordx4 v70, s[24:27], s59 offen offset:2048 lds
    s_waitcnt lgkmcnt(10)
    v_mfma_f32_32x32x16_bf16 v[192:207], a[120:123], a[152:155], v[192:207]
    ds_read_b64_tr_b16 a[80:81], v99 offset:16384
    ds_read_b64_tr_b16 a[82:83], v99 offset:24576
    buffer_load_dwordx4 v71, s[24:27], s59 offen offset:3072 lds
    s_add_u32 s59, s59, 0x7000
    s_cmp_ge_u32 s59, s74
    s_cselect_b32 s60, 0x70000, 0
    s_sub_u32 s59, s59, s60
    s_waitcnt lgkmcnt(10)
    v_mfma_f32_32x32x16_bf16 v[208:223], a[124:127], a[152:155], v[208:223]
    ds_read_b64_tr_b16 a[84:85], v100 offset:16384
    ds_read_b64_tr_b16 a[86:87], v100 offset:24576
    s_waitcnt lgkmcnt(10)
    v_mfma_f32_32x32x16_bf16 v[224:239], a[64:67], a[152:155], v[224:239]
    ds_read_b64_tr_b16 a[88:89], v101 offset:16384
    ds_read_b64_tr_b16 a[90:91], v101 offset:24576
    s_waitcnt lgkmcnt(10)
    v_mfma_f32_32x32x16_bf16 v[128:143], a[68:71], a[156:159], v[128:143]
    ds_read_b64_tr_b16 a[92:93], v102 offset:16384
    ds_read_b64_tr_b16 a[94:95], v102 offset:24576
    s_waitcnt lgkmcnt(10)
    v_mfma_f32_32x32x16_bf16 v[144:159], a[72:75], a[156:159], v[144:159]
    s_waitcnt lgkmcnt(8)
    v_mfma_f32_32x32x16_bf16 v[160:175], a[76:79], a[156:159], v[160:175]
    s_waitcnt lgkmcnt(6)
    v_mfma_f32_32x32x16_bf16 v[176:191], a[80:83], a[156:159], v[176:191]
    s_waitcnt lgkmcnt(4)
    v_mfma_f32_32x32x16_bf16 v[192:207], a[84:87], a[156:159], v[192:207]
    s_waitcnt lgkmcnt(0)
    s_waitcnt vmcnt(24)
    s_barrier
    v_add_u32 v38, 0x8000, v46
    v_add_u32 v39, 0x8000, v47
    v_add_u32 v40, 0x8000, v48
    v_add_u32 v41, 0x8000, v49
    v_add_u32 v42, 0x8000, v50
    v_add_u32 v43, 0x8000, v51
    v_add_u32 v44, 0x8000, v52
    ds_read_b64_tr_b16 a[96:97], v38 offset:0
    ds_read_b64_tr_b16 a[98:99], v38 offset:8192
    ds_read_b64_tr_b16 a[100:101], v39 offset:0
    ds_read_b64_tr_b16 a[102:103], v39 offset:8192
    ds_read_b64_tr_b16 a[104:105], v40 offset:0
    ds_read_b64_tr_b16 a[106:107], v40 offset:8192
    ds_read_b64_tr_b16 a[108:109], v41 offset:0
    ds_read_b64_tr_b16 a[110:111], v41 offset:8192
    s_add_u32 m0, s32, 0x0
    s_nop 0
    buffer_load_dwordx4 v8, s[24:27], s59 offen offset:0 lds
    s_waitcnt lgkmcnt(10)
    v_mfma_f32_32x32x16_bf16 v[208:223], a[88:91], a[156:159], v[208:223]
    ds_read_b64_tr_b16 a[112:113], v42 offset:0
    ds_read_b64_tr_b16 a[114:115], v42 offset:8192
    buffer_load_dwordx4 v9, s[24:27], s59 offen offset:1024 lds
    s_waitcnt lgkmcnt(10)
    v_mfma_f32_32x32x16_bf16 v[224:239], a[92:95], a[156:159], v[224:239]
    ds_read_b64_tr_b16 a[116:117], v43 offset:0
    ds_read_b64_tr_b16 a[118:119], v43 offset:8192
    buffer_load_dwordx4 v10, s[24:27], s59 offen offset:2048 lds
    s_waitcnt lgkmcnt(10)
    v_mfma_f32_32x32x16_bf16 v[128:143], a[96:99], a[160:163], v[128:143]
    ds_read_b64_tr_b16 a[120:121], v44 offset:0
    ds_read_b64_tr_b16 a[122:123], v44 offset:8192
    buffer_load_dwordx4 v11, s[24:27], s59 offen offset:3072 lds
    s_waitcnt lgkmcnt(10)
    v_mfma_f32_32x32x16_bf16 v[144:159], a[100:103], a[160:163], v[144:159]
    ds_read_b64_tr_b16 a[124:125], v38 offset:16384
    ds_read_b64_tr_b16 a[126:127], v38 offset:24576
    s_add_u32 m0, s32, 0x1000
    s_nop 0
    buffer_load_dwordx4 v68, s[24:27], s59 offen offset:0 lds
    s_waitcnt lgkmcnt(10)
    v_mfma_f32_32x32x16_bf16 v[160:175], a[104:107], a[160:163], v[160:175]
    ds_read_b64_tr_b16 a[64:65], v39 offset:16384
    ds_read_b64_tr_b16 a[66:67], v39 offset:24576
    buffer_load_dwordx4 v69, s[24:27], s59 offen offset:1024 lds
    s_waitcnt lgkmcnt(10)
    v_mfma_f32_32x32x16_bf16 v[176:191], a[108:111], a[160:163], v[176:191]
    ds_read_b64_tr_b16 a[68:69], v40 offset:16384
    ds_read_b64_tr_b16 a[70:71], v40 offset:24576
    buffer_load_dwordx4 v70, s[24:27], s59 offen offset:2048 lds
    s_waitcnt lgkmcnt(10)
    v_mfma_f32_32x32x16_bf16 v[192:207], a[112:115], a[160:163], v[192:207]
    ds_read_b64_tr_b16 a[72:73], v41 offset:16384
    ds_read_b64_tr_b16 a[74:75], v41 offset:24576
    buffer_load_dwordx4 v71, s[24:27], s59 offen offset:3072 lds
    s_add_u32 s59, s59, 0x7000
    s_cmp_ge_u32 s59, s74
    s_cselect_b32 s60, 0x70000, 0
    s_sub_u32 s59, s59, s60
    s_waitcnt lgkmcnt(10)
    v_mfma_f32_32x32x16_bf16 v[208:223], a[116:119], a[160:163], v[208:223]
    ds_read_b64_tr_b16 a[76:77], v42 offset:16384
    ds_read_b64_tr_b16 a[78:79], v42 offset:24576
    s_waitcnt lgkmcnt(10)
    v_mfma_f32_32x32x16_bf16 v[224:239], a[120:123], a[160:163], v[224:239]
    ds_read_b64_tr_b16 a[80:81], v43 offset:16384
    ds_read_b64_tr_b16 a[82:83], v43 offset:24576
    s_waitcnt lgkmcnt(10)
    v_mfma_f32_32x32x16_bf16 v[128:143], a[124:127], a[164:167], v[128:143]
    ds_read_b64_tr_b16 a[84:85], v44 offset:16384
    ds_read_b64_tr_b16 a[86:87], v44 offset:24576
    s_waitcnt lgkmcnt(10)
    v_mfma_f32_32x32x16_bf16 v[144:159], a[64:67], a[164:167], v[144:159]
    s_waitcnt lgkmcnt(8)
    v_mfma_f32_32x32x16_bf16 v[160:175], a[68:71], a[164:167], v[160:175]
    s_waitcnt lgkmcnt(6)
    v_mfma_f32_32x32x16_bf16 v[176:191], a[72:75], a[164:167], v[176:191]
    s_waitcnt lgkmcnt(4)
    v_mfma_f32_32x32x16_bf16 v[192:207], a[76:79], a[164:167], v[192:207]
    s_waitcnt lgkmcnt(0)
    s_waitcnt vmcnt(24)
    s_barrier
    v_add_u32 v96, 0x10000, v46
    v_add_u32 v97, 0x10000, v47
    v_add_u32 v98, 0x10000, v48
    v_add_u32 v99, 0x10000, v49
    v_add_u32 v100, 0x10000, v50
    v_add_u32 v101, 0x10000, v51
    v_add_u32 v102, 0x10000, v52
    ds_read_b64_tr_b16 a[88:89], v96 offset:0
    ds_read_b64_tr_b16 a[90:91], v96 offset:8192
    ds_read_b64_tr_b16 a[92:93], v97 offset:0
    ds_read_b64_tr_b16 a[94:95], v97 offset:8192
    ds_read_b64_tr_b16 a[96:97], v98 offset:0
    ds_read_b64_tr_b16 a[98:99], v98 offset:8192
    ds_read_b64_tr_b16 a[100:101], v99 offset:0
    ds_read_b64_tr_b16 a[102:103], v99 offset:8192
    s_add_u32 m0, s32, 0x8000
    s_nop 0
    buffer_load_dwordx4 v8, s[24:27], s59 offen offset:0 lds
    s_waitcnt lgkmcnt(10)
    v_mfma_f32_32x32x16_bf16 v[208:223], a[80:83], a[164:167], v[208:223]
    ds_read_b64_tr_b16 a[104:105], v100 offset:0
    ds_read_b64_tr_b16 a[106:107], v100 offset:8192
    buffer_load_dwordx4 v9, s[24:27], s59 offen offset:1024 lds
    s_waitcnt lgkmcnt(10)
    v_mfma_f32_32x32x16_bf16 v[224:239], a[84:87], a[164:167], v[224:239]
    ds_read_b64_tr_b16 a[108:109], v101 offset:0
    ds_read_b64_tr_b16 a[110:111], v101 offset:8192
    buffer_load_dwordx4 v10, s[24:27], s59 offen offset:2048 lds
    s_waitcnt lgkmcnt(10)
    v_mfma_f32_32x32x16_bf16 v[128:143], a[88:91], a[168:171], v[128:143]
    ds_read_b64_tr_b16 a[112:113], v102 offset:0
    ds_read_b64_tr_b16 a[114:115], v102 offset:8192
    buffer_load_dwordx4 v11, s[24:27], s59 offen offset:3072 lds
    s_waitcnt lgkmcnt(10)
    v_mfma_f32_32x32x16_bf16 v[144:159], a[92:95], a[168:171], v[144:159]
    ds_read_b64_tr_b16 a[116:117], v96 offset:16384
    ds_read_b64_tr_b16 a[118:119], v96 offset:24576
    s_add_u32 m0, s32, 0x9000
    s_nop 0
    buffer_load_dwordx4 v68, s[24:27], s59 offen offset:0 lds
    s_waitcnt lgkmcnt(10)
    v_mfma_f32_32x32x16_bf16 v[160:175], a[96:99], a[168:171], v[160:175]
    ds_read_b64_tr_b16 a[120:121], v97 offset:16384
    ds_read_b64_tr_b16 a[122:123], v97 offset:24576
    buffer_load_dwordx4 v69, s[24:27], s59 offen offset:1024 lds
    s_waitcnt lgkmcnt(10)
    v_mfma_f32_32x32x16_bf16 v[176:191], a[100:103], a[168:171], v[176:191]
    ds_read_b64_tr_b16 a[124:125], v98 offset:16384
    ds_read_b64_tr_b16 a[126:127], v98 offset:24576
    buffer_load_dwordx4 v70, s[24:27], s59 offen offset:2048 lds
    s_waitcnt lgkmcnt(10)
    v_mfma_f32_32x32x16_bf16 v[192:207], a[104:107], a[168:171], v[192:207]
    ds_read_b64_tr_b16 a[64:65], v99 offset:16384
    ds_read_b64_tr_b16 a[66:67], v99 offset:24576
    buffer_load_dwordx4 v71, s[24:27], s59 offen offset:3072 lds
    s_add_u32 s59, s59, 0x7000
    s_cmp_ge_u32 s59, s74
    s_cselect_b32 s60, 0x70000, 0
    s_sub_u32 s59, s59, s60
    s_waitcnt lgkmcnt(10)
    v_mfma_f32_32x32x16_bf16 v[208:223], a[108:111], a[168:171], v[208:223]
    ds_read_b64_tr_b16 a[68:69], v100 offset:16384
    ds_read_b64_tr_b16 a[70:71], v100 offset:24576
    s_waitcnt lgkmcnt(10)
    v_mfma_f32_32x32x16_bf16 v[224:239], a[112:115], a[168:171], v[224:239]
    ds_read_b64_tr_b16 a[72:73], v101 offset:16384
    ds_read_b64_tr_b16 a[74:75], v101 offset:24576
    s_waitcnt lgkmcnt(10)
    v_mfma_f32_32x32x16_bf16 v[128:143], a[116:119], a[172:175], v[128:143]
    ds_read_b64_tr_b16 a[76:77], v102 offset:16384
    ds_read_b64_tr_b16 a[78:79], v102 offset:24576
    s_waitcnt lgkmcnt(10)
    v_mfma_f32_32x32x16_bf16 v[144:159], a[120:123], a[172:175], v[144:159]
    s_waitcnt lgkmcnt(8)
    v_mfma_f32_32x32x16_bf16 v[160:175], a[124:127], a[172:175], v[160:175]
    s_waitcnt lgkmcnt(6)
    v_mfma_f32_32x32x16_bf16 v[176:191], a[64:67], a[172:175], v[176:191]
    s_waitcnt lgkmcnt(4)
    v_mfma_f32_32x32x16_bf16 v[192:207], a[68:71], a[172:175], v[192:207]
    s_waitcnt lgkmcnt(0)
    s_waitcnt vmcnt(24)
    s_barrier
    v_add_u32 v38, 0x18000, v46
    v_add_u32 v39, 0x18000, v47
    v_add_u32 v40, 0x18000, v48
    v_add_u32 v41, 0x18000, v49
    v_add_u32 v42, 0x18000, v50
    v_add_u32 v43, 0x18000, v51
    v_add_u32 v44, 0x18000, v52
    ds_read_b64_tr_b16 a[80:81], v38 offset:0
    ds_read_b64_tr_b16 a[82:83], v38 offset:8192
    ds_read_b64_tr_b16 a[84:85], v39 offset:0
    ds_read_b64_tr_b16 a[86:87], v39 offset:8192
    ds_read_b64_tr_b16 a[88:89], v40 offset:0
    ds_read_b64_tr_b16 a[90:91], v40 offset:8192
    ds_read_b64_tr_b16 a[92:93], v41 offset:0
    ds_read_b64_tr_b16 a[94:95], v41 offset:8192
    s_add_u32 m0, s32, 0x10000
    s_nop 0
    buffer_load_dwordx4 v8, s[24:27], s59 offen offset:0 lds
    s_waitcnt lgkmcnt(10)
    v_mfma_f32_32x32x16_bf16 v[208:223], a[72:75], a[172:175], v[208:223]
    ds_read_b64_tr_b16 a[96:97], v42 offset:0
    ds_read_b64_tr_b16 a[98:99], v42 offset:8192
    buffer_load_dwordx4 v9, s[24:27], s59 offen offset:1024 lds
    s_waitcnt lgkmcnt(10)
    v_mfma_f32_32x32x16_bf16 v[224:239], a[76:79], a[172:175], v[224:239]
    ds_read_b64_tr_b16 a[100:101], v43 offset:0
    ds_read_b64_tr_b16 a[102:103], v43 offset:8192
    buffer_load_dwordx4 v10, s[24:27], s59 offen offset:2048 lds
    s_waitcnt lgkmcnt(10)
    v_mfma_f32_32x32x16_bf16 v[128:143], a[80:83], a[176:179], v[128:143]
    ds_read_b64_tr_b16 a[104:105], v44 offset:0
    ds_read_b64_tr_b16 a[106:107], v44 offset:8192
    buffer_load_dwordx4 v11, s[24:27], s59 offen offset:3072 lds
    s_waitcnt lgkmcnt(10)
    v_mfma_f32_32x32x16_bf16 v[144:159], a[84:87], a[176:179], v[144:159]
    ds_read_b64_tr_b16 a[108:109], v38 offset:16384
    ds_read_b64_tr_b16 a[110:111], v38 offset:24576
    s_add_u32 m0, s32, 0x11000
    s_nop 0
    buffer_load_dwordx4 v68, s[24:27], s59 offen offset:0 lds
    s_waitcnt lgkmcnt(10)
    v_mfma_f32_32x32x16_bf16 v[160:175], a[88:91], a[176:179], v[160:175]
    ds_read_b64_tr_b16 a[112:113], v39 offset:16384
    ds_read_b64_tr_b16 a[114:115], v39 offset:24576
    buffer_load_dwordx4 v69, s[24:27], s59 offen offset:1024 lds
    s_waitcnt lgkmcnt(10)
    v_mfma_f32_32x32x16_bf16 v[176:191], a[92:95], a[176:179], v[176:191]
    ds_read_b64_tr_b16 a[116:117], v40 offset:16384
    ds_read_b64_tr_b16 a[118:119], v40 offset:24576
    buffer_load_dwordx4 v70, s[24:27], s59 offen offset:2048 lds
    s_waitcnt lgkmcnt(10)
    v_mfma_f32_32x32x16_bf16 v[192:207], a[96:99], a[176:179], v[192:207]
    ds_read_b64_tr_b16 a[120:121], v41 offset:16384
    ds_read_b64_tr_b16 a[122:123], v41 offset:24576
    buffer_load_dwordx4 v71, s[24:27], s59 offen offset:3072 lds
    s_add_u32 s59, s59, 0x7000
    s_cmp_ge_u32 s59, s74
    s_cselect_b32 s60, 0x70000, 0
    s_sub_u32 s59, s59, s60
    s_waitcnt lgkmcnt(10)
    v_mfma_f32_32x32x16_bf16 v[208:223], a[100:103], a[176:179], v[208:223]
    ds_read_b64_tr_b16 a[124:125], v42 offset:16384
    ds_read_b64_tr_b16 a[126:127], v42 offset:24576
    s_waitcnt lgkmcnt(10)
    v_mfma_f32_32x32x16_bf16 v[224:239], a[104:107], a[176:179], v[224:239]
    ds_read_b64_tr_b16 a[64:65], v43 offset:16384
    ds_read_b64_tr_b16 a[66:67], v43 offset:24576
    s_waitcnt lgkmcnt(10)
    v_mfma_f32_32x32x16_bf16 v[128:143], a[108:111], a[180:183], v[128:143]
    ds_read_b64_tr_b16 a[68:69], v44 offset:16384
    ds_read_b64_tr_b16 a[70:71], v44 offset:24576
    s_waitcnt lgkmcnt(10)
    v_mfma_f32_32x32x16_bf16 v[144:159], a[112:115], a[180:183], v[144:159]
    s_waitcnt lgkmcnt(8)
    v_mfma_f32_32x32x16_bf16 v[160:175], a[116:119], a[180:183], v[160:175]
    s_waitcnt lgkmcnt(6)
    v_mfma_f32_32x32x16_bf16 v[176:191], a[120:123], a[180:183], v[176:191]
    s_waitcnt lgkmcnt(4)
    v_mfma_f32_32x32x16_bf16 v[192:207], a[124:127], a[180:183], v[192:207]
    s_waitcnt lgkmcnt(0)
    s_waitcnt vmcnt(24)
    s_barrier
    v_add_u32 v96, 0x20000, v46
    v_add_u32 v97, 0x20000, v47
    v_add_u32 v98, 0x20000, v48
    v_add_u32 v99, 0x20000, v49
    v_add_u32 v100, 0x20000, v50
    v_add_u32 v101, 0x20000, v51
    v_add_u32 v102, 0x20000, v52
    ds_read_b64_tr_b16 a[72:73], v96 offset:0
    ds_read_b64_tr_b16 a[74:75], v96 offset:8192
    ds_read_b64_tr_b16 a[76:77], v97 offset:0
    ds_read_b64_tr_b16 a[78:79], v97 offset:8192
    ds_read_b64_tr_b16 a[80:81], v98 offset:0
    ds_read_b64_tr_b16 a[82:83], v98 offset:8192
    ds_read_b64_tr_b16 a[84:85], v99 offset:0
    ds_read_b64_tr_b16 a[86:87], v99 offset:8192
    s_add_u32 m0, s32, 0x18000
    s_nop 0
    buffer_load_dwordx4 v8, s[24:27], s59 offen offset:0 lds
    s_waitcnt lgkmcnt(10)
    v_mfma_f32_32x32x16_bf16 v[208:223], a[64:67], a[180:183], v[208:223]
    ds_read_b64_tr_b16 a[88:89], v100 offset:0
    ds_read_b64_tr_b16 a[90:91], v100 offset:8192
    buffer_load_dwordx4 v9, s[24:27], s59 offen offset:1024 lds
    s_waitcnt lgkmcnt(10)
    v_mfma_f32_32x32x16_bf16 v[224:239], a[68:71], a[180:183], v[224:239]
    ds_read_b64_tr_b16 a[92:93], v101 offset:0
    ds_read_b64_tr_b16 a[94:95], v101 offset:8192
    buffer_load_dwordx4 v10, s[24:27], s59 offen offset:2048 lds
    s_waitcnt lgkmcnt(10)
    v_mfma_f32_32x32x16_bf16 v[128:143], a[72:75], a[184:187], v[128:143]
    ds_read_b64_tr_b16 a[96:97], v102 offset:0
    ds_read_b64_tr_b16 a[98:99], v102 offset:8192
    buffer_load_dwordx4 v11, s[24:27], s59 offen offset:3072 lds
    s_waitcnt lgkmcnt(10)
    v_mfma_f32_32x32x16_bf16 v[144:159], a[76:79], a[184:187], v[144:159]
    ds_read_b64_tr_b16 a[100:101], v96 offset:16384
    ds_read_b64_tr_b16 a[102:103], v96 offset:24576
    s_add_u32 m0, s32, 0x19000
    s_nop 0
    buffer_load_dwordx4 v68, s[24:27], s59 offen offset:0 lds
    s_waitcnt lgkmcnt(10)
    v_mfma_f32_32x32x16_bf16 v[160:175], a[80:83], a[184:187], v[160:175]
    ds_read_b64_tr_b16 a[104:105], v97 offset:16384
    ds_read_b64_tr_b16 a[106:107], v97 offset:24576
    buffer_load_dwordx4 v69, s[24:27], s59 offen offset:1024 lds
    s_waitcnt lgkmcnt(10)
    v_mfma_f32_32x32x16_bf16 v[176:191], a[84:87], a[184:187], v[176:191]
    ds_read_b64_tr_b16 a[108:109], v98 offset:16384
    ds_read_b64_tr_b16 a[110:111], v98 offset:24576
    buffer_load_dwordx4 v70, s[24:27], s59 offen offset:2048 lds
    s_waitcnt lgkmcnt(10)
    v_mfma_f32_32x32x16_bf16 v[192:207], a[88:91], a[184:187], v[192:207]
    ds_read_b64_tr_b16 a[112:113], v99 offset:16384
    ds_read_b64_tr_b16 a[114:115], v99 offset:24576
    buffer_load_dwordx4 v71, s[24:27], s59 offen offset:3072 lds
    s_add_u32 s59, s59, 0x7000
    s_cmp_ge_u32 s59, s74
    s_cselect_b32 s60, 0x70000, 0
    s_sub_u32 s59, s59, s60
    s_waitcnt lgkmcnt(10)
    v_mfma_f32_32x32x16_bf16 v[208:223], a[92:95], a[184:187], v[208:223]
    ds_read_b64_tr_b16 a[116:117], v100 offset:16384
    ds_read_b64_tr_b16 a[118:119], v100 offset:24576
    s_waitcnt lgkmcnt(10)
    v_mfma_f32_32x32x16_bf16 v[224:239], a[96:99], a[184:187], v[224:239]
    ds_read_b64_tr_b16 a[120:121], v101 offset:16384
    ds_read_b64_tr_b16 a[122:123], v101 offset:24576
    s_waitcnt lgkmcnt(10)
    v_mfma_f32_32x32x16_bf16 v[128:143], a[100:103], a[188:191], v[128:143]
    ds_read_b64_tr_b16 a[124:125], v102 offset:16384
    ds_read_b64_tr_b16 a[126:127], v102 offset:24576
    s_waitcnt lgkmcnt(10)
    v_mfma_f32_32x32x16_bf16 v[144:159], a[104:107], a[188:191], v[144:159]
    s_waitcnt lgkmcnt(8)
    v_mfma_f32_32x32x16_bf16 v[160:175], a[108:111], a[188:191], v[160:175]
    s_waitcnt lgkmcnt(6)
    v_mfma_f32_32x32x16_bf16 v[176:191], a[112:115], a[188:191], v[176:191]
    s_waitcnt lgkmcnt(4)
    v_mfma_f32_32x32x16_bf16 v[192:207], a[116:119], a[188:191], v[192:207]
    s_waitcnt lgkmcnt(0)
    s_waitcnt vmcnt(24)
    s_barrier
    v_add_u32 v38, 0x0, v46
    v_add_u32 v39, 0x0, v47
    v_add_u32 v40, 0x0, v48
    v_add_u32 v41, 0x0, v49
    v_add_u32 v42, 0x0, v50
    v_add_u32 v43, 0x0, v51
    v_add_u32 v44, 0x0, v52
    ds_read_b64_tr_b16 a[64:65], v38 offset:0
    ds_read_b64_tr_b16 a[66:67], v38 offset:8192
    ds_read_b64_tr_b16 a[68:69], v39 offset:0
    ds_read_b64_tr_b16 a[70:71], v39 offset:8192
    ds_read_b64_tr_b16 a[72:73], v40 offset:0
    ds_read_b64_tr_b16 a[74:75], v40 offset:8192
    ds_read_b64_tr_b16 a[76:77], v41 offset:0
    ds_read_b64_tr_b16 a[78:79], v41 offset:8192
    s_add_u32 m0, s32, 0x20000
    s_nop 0
    buffer_load_dwordx4 v8, s[24:27], s59 offen offset:0 lds
    s_waitcnt lgkmcnt(10)
    v_mfma_f32_32x32x16_bf16 v[208:223], a[120:123], a[188:191], v[208:223]
    ds_read_b64_tr_b16 a[80:81], v42 offset:0
    ds_read_b64_tr_b16 a[82:83], v42 offset:8192
    buffer_load_dwordx4 v9, s[24:27], s59 offen offset:1024 lds
    s_waitcnt lgkmcnt(10)
    v_mfma_f32_32x32x16_bf16 v[224:239], a[124:127], a[188:191], v[224:239]
    ds_read_b64_tr_b16 a[84:85], v43 offset:0
    ds_read_b64_tr_b16 a[86:87], v43 offset:8192
    buffer_load_dwordx4 v10, s[24:27], s59 offen offset:2048 lds
    s_waitcnt lgkmcnt(10)
    v_mfma_f32_32x32x16_bf16 v[128:143], a[64:67], a[192:195], v[128:143]
    ds_read_b64_tr_b16 a[88:89], v44 offset:0
    ds_read_b64_tr_b16 a[90:91], v44 offset:8192
    buffer_load_dwordx4 v11, s[24:27], s59 offen offset:3072 lds
    s_waitcnt lgkmcnt(10)
    v_mfma_f32_32x32x16_bf16 v[144:159], a[68:71], a[192:195], v[144:159]
    ds_read_b64_tr_b16 a[92:93], v38 offset:16384
    ds_read_b64_tr_b16 a[94:95], v38 offset:24576
    s_add_u32 m0, s32, 0x21000
    s_nop 0
    buffer_load_dwordx4 v68, s[24:27], s59 offen offset:0 lds
    s_waitcnt lgkmcnt(10)
    v_mfma_f32_32x32x16_bf16 v[160:175], a[72:75], a[192:195], v[160:175]
    ds_read_b64_tr_b16 a[96:97], v39 offset:16384
    ds_read_b64_tr_b16 a[98:99], v39 offset:24576
    buffer_load_dwordx4 v69, s[24:27], s59 offen offset:1024 lds
    s_waitcnt lgkmcnt(10)
    v_mfma_f32_32x32x16_bf16 v[176:191], a[76:79], a[192:195], v[176:191]
    ds_read_b64_tr_b16 a[100:101], v40 offset:16384
    ds_read_b64_tr_b16 a[102:103], v40 offset:24576
    buffer_load_dwordx4 v70, s[24:27], s59 offen offset:2048 lds
    s_waitcnt lgkmcnt(10)
    v_mfma_f32_32x32x16_bf16 v[192:207], a[80:83], a[192:195], v[192:207]
    ds_read_b64_tr_b16 a[104:105], v41 offset:16384
    ds_read_b64_tr_b16 a[106:107], v41 offset:24576
    buffer_load_dwordx4 v71, s[24:27], s59 offen offset:3072 lds
    s_add_u32 s59, s59, 0x7000
    s_cmp_ge_u32 s59, s74
    s_cselect_b32 s60, 0x70000, 0
    s_sub_u32 s59, s59, s60
    s_waitcnt lgkmcnt(10)
    v_mfma_f32_32x32x16_bf16 v[208:223], a[84:87], a[192:195], v[208:223]
    ds_read_b64_tr_b16 a[108:109], v42 offset:16384
    ds_read_b64_tr_b16 a[110:111], v42 offset:24576
    s_waitcnt lgkmcnt(10)
    v_mfma_f32_32x32x16_bf16 v[224:239], a[88:91], a[192:195], v[224:239]
    ds_read_b64_tr_b16 a[112:113], v43 offset:16384
    ds_read_b64_tr_b16 a[114:115], v43 offset:24576
    s_waitcnt lgkmcnt(10)
    v_mfma_f32_32x32x16_bf16 v[128:143], a[92:95], a[196:199], v[128:143]
    ds_read_b64_tr_b16 a[116:117], v44 offset:16384
    ds_read_b64_tr_b16 a[118:119], v44 offset:24576
    s_waitcnt lgkmcnt(10)
    v_mfma_f32_32x32x16_bf16 v[144:159], a[96:99], a[196:199], v[144:159]
    s_waitcnt lgkmcnt(8)
    v_mfma_f32_32x32x16_bf16 v[160:175], a[100:103], a[196:199], v[160:175]
    s_waitcnt lgkmcnt(6)
    v_mfma_f32_32x32x16_bf16 v[176:191], a[104:107], a[196:199], v[176:191]
    s_waitcnt lgkmcnt(4)
    v_mfma_f32_32x32x16_bf16 v[192:207], a[108:111], a[196:199], v[192:207]
    s_waitcnt lgkmcnt(0)
    s_waitcnt vmcnt(24)
    s_barrier
    v_add_u32 v96, 0x8000, v46
    v_add_u32 v97, 0x8000, v47
    v_add_u32 v98, 0x8000, v48
    v_add_u32 v99, 0x8000, v49
    v_add_u32 v100, 0x8000, v50
    v_add_u32 v101, 0x8000, v51
    v_add_u32 v102, 0x8000, v52
    ds_read_b64_tr_b16 a[120:121], v96 offset:0
    ds_read_b64_tr_b16 a[122:123], v96 offset:8192
    ds_read_b64_tr_b16 a[124:125], v97 offset:0
    ds_read_b64_tr_b16 a[126:127], v97 offset:8192
    ds_read_b64_tr_b16 a[64:65], v98 offset:0
    ds_read_b64_tr_b16 a[66:67], v98 offset:8192
    ds_read_b64_tr_b16 a[68:69], v99 offset:0
    ds_read_b64_tr_b16 a[70:71], v99 offset:8192
    s_add_u32 m0, s32, 0x0
    s_nop 0
    buffer_load_dwordx4 v8, s[24:27], s59 offen offset:0 lds
    s_waitcnt lgkmcnt(10)
    v_mfma_f32_32x32x16_bf16 v[208:223], a[112:115], a[196:199], v[208:223]
    ds_read_b64_tr_b16 a[72:73], v100 offset:0
    ds_read_b64_tr_b16 a[74:75], v100 offset:8192
    buffer_load_dwordx4 v9, s[24:27], s59 offen offset:1024 lds
    s_waitcnt lgkmcnt(10)
    v_mfma_f32_32x32x16_bf16 v[224:239], a[116:119], a[196:199], v[224:239]
    ds_read_b64_tr_b16 a[76:77], v101 offset:0
    ds_read_b64_tr_b16 a[78:79], v101 offset:8192
    buffer_load_dwordx4 v10, s[24:27], s59 offen offset:2048 lds
    s_waitcnt lgkmcnt(10)
    v_mfma_f32_32x32x16_bf16 v[128:143], a[120:123], a[200:203], v[128:143]
    ds_read_b64_tr_b16 a[80:81], v102 offset:0
    ds_read_b64_tr_b16 a[82:83], v102 offset:8192
    buffer_load_dwordx4 v11, s[24:27], s59 offen offset:3072 lds
    s_waitcnt lgkmcnt(10)
    v_mfma_f32_32x32x16_bf16 v[144:159], a[124:127], a[200:203], v[144:159]
    ds_read_b64_tr_b16 a[84:85], v96 offset:16384
    ds_read_b64_tr_b16 a[86:87], v96 offset:24576
    s_add_u32 m0, s32, 0x1000
    s_nop 0
    buffer_load_dwordx4 v68, s[24:27], s59 offen offset:0 lds
    s_waitcnt lgkmcnt(10)
    v_mfma_f32_32x32x16_bf16 v[160:175], a[64:67], a[200:203], v[160:175]
    ds_read_b64_tr_b16 a[88:89], v97 offset:16384
    ds_read_b64_tr_b16 a[90:91], v97 offset:24576
    buffer_load_dwordx4 v69, s[24:27], s59 offen offset:1024 lds
    s_waitcnt lgkmcnt(10)
    v_mfma_f32_32x32x16_bf16 v[176:191], a[68:71], a[200:203], v[176:191]
    ds_read_b64_tr_b16 a[92:93], v98 offset:16384
    ds_read_b64_tr_b16 a[94:95], v98 offset:24576
    buffer_load_dwordx4 v70, s[24:27], s59 offen offset:2048 lds
    s_waitcnt lgkmcnt(10)
    v_mfma_f32_32x32x16_bf16 v[192:207], a[72:75], a[200:203], v[192:207]
    ds_read_b64_tr_b16 a[96:97], v99 offset:16384
    ds_read_b64_tr_b16 a[98:99], v99 offset:24576
    buffer_load_dwordx4 v71, s[24:27], s59 offen offset:3072 lds
    s_add_u32 s59, s59, 0x7000
    s_cmp_ge_u32 s59, s74
    s_cselect_b32 s60, 0x70000, 0
    s_sub_u32 s59, s59, s60
    s_waitcnt lgkmcnt(10)
    v_mfma_f32_32x32x16_bf16 v[208:223], a[76:79], a[200:203], v[208:223]
    ds_read_b64_tr_b16 a[100:101], v100 offset:16384
    ds_read_b64_tr_b16 a[102:103], v100 offset:24576
    s_waitcnt lgkmcnt(10)
    v_mfma_f32_32x32x16_bf16 v[224:239], a[80:83], a[200:203], v[224:239]
    ds_read_b64_tr_b16 a[104:105], v101 offset:16384
    ds_read_b64_tr_b16 a[106:107], v101 offset:24576
    s_waitcnt lgkmcnt(10)
    v_mfma_f32_32x32x16_bf16 v[128:143], a[84:87], a[204:207], v[128:143]
    ds_read_b64_tr_b16 a[108:109], v102 offset:16384
    ds_read_b64_tr_b16 a[110:111], v102 offset:24576
    s_waitcnt lgkmcnt(10)
    v_mfma_f32_32x32x16_bf16 v[144:159], a[88:91], a[204:207], v[144:159]
    s_waitcnt lgkmcnt(8)
    v_mfma_f32_32x32x16_bf16 v[160:175], a[92:95], a[204:207], v[160:175]
    s_waitcnt lgkmcnt(6)
    v_mfma_f32_32x32x16_bf16 v[176:191], a[96:99], a[204:207], v[176:191]
    s_waitcnt lgkmcnt(4)
    v_mfma_f32_32x32x16_bf16 v[192:207], a[100:103], a[204:207], v[192:207]
    s_waitcnt lgkmcnt(0)
    s_waitcnt vmcnt(24)
    s_barrier
    v_add_u32 v38, 0x10000, v46
    v_add_u32 v39, 0x10000, v47
    v_add_u32 v40, 0x10000, v48
    v_add_u32 v41, 0x10000, v49
    v_add_u32 v42, 0x10000, v50
    v_add_u32 v43, 0x10000, v51
    v_add_u32 v44, 0x10000, v52
    ds_read_b64_tr_b16 a[112:113], v38 offset:0
    ds_read_b64_tr_b16 a[114:115], v38 offset:8192
    ds_read_b64_tr_b16 a[116:117], v39 offset:0
    ds_read_b64_tr_b16 a[118:119], v39 offset:8192
    ds_read_b64_tr_b16 a[120:121], v40 offset:0
    ds_read_b64_tr_b16 a[122:123], v40 offset:8192
    ds_read_b64_tr_b16 a[124:125], v41 offset:0
    ds_read_b64_tr_b16 a[126:127], v41 offset:8192
    s_add_u32 m0, s32, 0x8000
    s_nop 0
    buffer_load_dwordx4 v8, s[24:27], s59 offen offset:0 lds
    s_waitcnt lgkmcnt(10)
    v_mfma_f32_32x32x16_bf16 v[208:223], a[104:107], a[204:207], v[208:223]
    ds_read_b64_tr_b16 a[64:65], v42 offset:0
    ds_read_b64_tr_b16 a[66:67], v42 offset:8192
    buffer_load_dwordx4 v9, s[24:27], s59 offen offset:1024 lds
    s_waitcnt lgkmcnt(10)
    v_mfma_f32_32x32x16_bf16 v[224:239], a[108:111], a[204:207], v[224:239]
    ds_read_b64_tr_b16 a[68:69], v43 offset:0
    ds_read_b64_tr_b16 a[70:71], v43 offset:8192
    buffer_load_dwordx4 v10, s[24:27], s59 offen offset:2048 lds
    s_waitcnt lgkmcnt(10)
    v_mfma_f32_32x32x16_bf16 v[128:143], a[112:115], a[208:211], v[128:143]
    ds_read_b64_tr_b16 a[72:73], v44 offset:0
    ds_read_b64_tr_b16 a[74:75], v44 offset:8192
    buffer_load_dwordx4 v11, s[24:27], s59 offen offset:3072 lds
    s_waitcnt lgkmcnt(10)
    v_mfma_f32_32x32x16_bf16 v[144:159], a[116:119], a[208:211], v[144:159]
    ds_read_b64_tr_b16 a[76:77], v38 offset:16384
    ds_read_b64_tr_b16 a[78:79], v38 offset:24576
    s_add_u32 m0, s32, 0x9000
    s_nop 0
    buffer_load_dwordx4 v68, s[24:27], s59 offen offset:0 lds
    s_waitcnt lgkmcnt(10)
    v_mfma_f32_32x32x16_bf16 v[160:175], a[120:123], a[208:211], v[160:175]
    ds_read_b64_tr_b16 a[80:81], v39 offset:16384
    ds_read_b64_tr_b16 a[82:83], v39 offset:24576
    buffer_load_dwordx4 v69, s[24:27], s59 offen offset:1024 lds
    s_waitcnt lgkmcnt(10)
    v_mfma_f32_32x32x16_bf16 v[176:191], a[124:127], a[208:211], v[176:191]
    ds_read_b64_tr_b16 a[84:85], v40 offset:16384
    ds_read_b64_tr_b16 a[86:87], v40 offset:24576
    buffer_load_dwordx4 v70, s[24:27], s59 offen offset:2048 lds
    s_waitcnt lgkmcnt(10)
    v_mfma_f32_32x32x16_bf16 v[192:207], a[64:67], a[208:211], v[192:207]
    ds_read_b64_tr_b16 a[88:89], v41 offset:16384
    ds_read_b64_tr_b16 a[90:91], v41 offset:24576
    buffer_load_dwordx4 v71, s[24:27], s59 offen offset:3072 lds
    s_add_u32 s59, s59, 0x7000
    s_cmp_ge_u32 s59, s74
    s_cselect_b32 s60, 0x70000, 0
    s_sub_u32 s59, s59, s60
    s_waitcnt lgkmcnt(10)
    v_mfma_f32_32x32x16_bf16 v[208:223], a[68:71], a[208:211], v[208:223]
    ds_read_b64_tr_b16 a[92:93], v42 offset:16384
    ds_read_b64_tr_b16 a[94:95], v42 offset:24576
    s_waitcnt lgkmcnt(10)
    v_mfma_f32_32x32x16_bf16 v[224:239], a[72:75], a[208:211], v[224:239]
    ds_read_b64_tr_b16 a[96:97], v43 offset:16384
    ds_read_b64_tr_b16 a[98:99], v43 offset:24576
    s_waitcnt lgkmcnt(10)
    v_mfma_f32_32x32x16_bf16 v[128:143], a[76:79], a[212:215], v[128:143]
    ds_read_b64_tr_b16 a[100:101], v44 offset:16384
    ds_read_b64_tr_b16 a[102:103], v44 offset:24576
    s_waitcnt lgkmcnt(10)
    v_mfma_f32_32x32x16_bf16 v[144:159], a[80:83], a[212:215], v[144:159]
    s_waitcnt lgkmcnt(8)
    v_mfma_f32_32x32x16_bf16 v[160:175], a[84:87], a[212:215], v[160:175]
    s_waitcnt lgkmcnt(6)
    v_mfma_f32_32x32x16_bf16 v[176:191], a[88:91], a[212:215], v[176:191]
    s_waitcnt lgkmcnt(4)
    v_mfma_f32_32x32x16_bf16 v[192:207], a[92:95], a[212:215], v[192:207]
    s_waitcnt lgkmcnt(0)
    s_waitcnt vmcnt(24)
    s_barrier
    v_add_u32 v96, 0x18000, v46
    v_add_u32 v97, 0x18000, v47
    v_add_u32 v98, 0x18000, v48
    v_add_u32 v99, 0x18000, v49
    v_add_u32 v100, 0x18000, v50
    v_add_u32 v101, 0x18000, v51
    v_add_u32 v102, 0x18000, v52
    ds_read_b64_tr_b16 a[104:105], v96 offset:0
    ds_read_b64_tr_b16 a[106:107], v96 offset:8192
    ds_read_b64_tr_b16 a[108:109], v97 offset:0
    ds_read_b64_tr_b16 a[110:111], v97 offset:8192
    ds_read_b64_tr_b16 a[112:113], v98 offset:0
    ds_read_b64_tr_b16 a[114:115], v98 offset:8192
    ds_read_b64_tr_b16 a[116:117], v99 offset:0
    ds_read_b64_tr_b16 a[118:119], v99 offset:8192
    s_add_u32 m0, s32, 0x10000
    s_nop 0
    buffer_load_dwordx4 v8, s[24:27], s59 offen offset:0 lds
    s_waitcnt lgkmcnt(10)
    v_mfma_f32_32x32x16_bf16 v[208:223], a[96:99], a[212:215], v[208:223]
    ds_read_b64_tr_b16 a[120:121], v100 offset:0
    ds_read_b64_tr_b16 a[122:123], v100 offset:8192
    buffer_load_dwordx4 v9, s[24:27], s59 offen offset:1024 lds
    s_waitcnt lgkmcnt(10)
    v_mfma_f32_32x32x16_bf16 v[224:239], a[100:103], a[212:215], v[224:239]
    ds_read_b64_tr_b16 a[124:125], v101 offset:0
    ds_read_b64_tr_b16 a[126:127], v101 offset:8192
    buffer_load_dwordx4 v10, s[24:27], s59 offen offset:2048 lds
    s_waitcnt lgkmcnt(10)
    v_mfma_f32_32x32x16_bf16 v[128:143], a[104:107], a[216:219], v[128:143]
    ds_read_b64_tr_b16 a[64:65], v102 offset:0
    ds_read_b64_tr_b16 a[66:67], v102 offset:8192
    buffer_load_dwordx4 v11, s[24:27], s59 offen offset:3072 lds
    s_waitcnt lgkmcnt(10)
    v_mfma_f32_32x32x16_bf16 v[144:159], a[108:111], a[216:219], v[144:159]
    ds_read_b64_tr_b16 a[68:69], v96 offset:16384
    ds_read_b64_tr_b16 a[70:71], v96 offset:24576
    s_add_u32 m0, s32, 0x11000
    s_nop 0
    buffer_load_dwordx4 v68, s[24:27], s59 offen offset:0 lds
    s_waitcnt lgkmcnt(10)
    v_mfma_f32_32x32x16_bf16 v[160:175], a[112:115], a[216:219], v[160:175]
    ds_read_b64_tr_b16 a[72:73], v97 offset:16384
    ds_read_b64_tr_b16 a[74:75], v97 offset:24576
    buffer_load_dwordx4 v69, s[24:27], s59 offen offset:1024 lds
    s_waitcnt lgkmcnt(10)
    v_mfma_f32_32x32x16_bf16 v[176:191], a[116:119], a[216:219], v[176:191]
    ds_read_b64_tr_b16 a[76:77], v98 offset:16384
    ds_read_b64_tr_b16 a[78:79], v98 offset:24576
    buffer_load_dwordx4 v70, s[24:27], s59 offen offset:2048 lds
    s_waitcnt lgkmcnt(10)
    v_mfma_f32_32x32x16_bf16 v[192:207], a[120:123], a[216:219], v[192:207]
    ds_read_b64_tr_b16 a[80:81], v99 offset:16384
    ds_read_b64_tr_b16 a[82:83], v99 offset:24576
    buffer_load_dwordx4 v71, s[24:27], s59 offen offset:3072 lds
    s_add_u32 s59, s59, 0x7000
    s_cmp_ge_u32 s59, s74
    s_cselect_b32 s60, 0x70000, 0
    s_sub_u32 s59, s59, s60
    s_waitcnt lgkmcnt(10)
    v_mfma_f32_32x32x16_bf16 v[208:223], a[124:127], a[216:219], v[208:223]
    ds_read_b64_tr_b16 a[84:85], v100 offset:16384
    ds_read_b64_tr_b16 a[86:87], v100 offset:24576
    s_waitcnt lgkmcnt(10)
    v_mfma_f32_32x32x16_bf16 v[224:239], a[64:67], a[216:219], v[224:239]
    ds_read_b64_tr_b16 a[88:89], v101 offset:16384
    ds_read_b64_tr_b16 a[90:91], v101 offset:24576
    s_waitcnt lgkmcnt(10)
    v_mfma_f32_32x32x16_bf16 v[128:143], a[68:71], a[220:223], v[128:143]
    ds_read_b64_tr_b16 a[92:93], v102 offset:16384
    ds_read_b64_tr_b16 a[94:95], v102 offset:24576
    s_waitcnt lgkmcnt(10)
    v_mfma_f32_32x32x16_bf16 v[144:159], a[72:75], a[220:223], v[144:159]
    s_waitcnt lgkmcnt(8)
    v_mfma_f32_32x32x16_bf16 v[160:175], a[76:79], a[220:223], v[160:175]
    s_waitcnt lgkmcnt(6)
    v_mfma_f32_32x32x16_bf16 v[176:191], a[80:83], a[220:223], v[176:191]
    s_waitcnt lgkmcnt(4)
    v_mfma_f32_32x32x16_bf16 v[192:207], a[84:87], a[220:223], v[192:207]
    s_waitcnt lgkmcnt(0)
    s_waitcnt vmcnt(24)
    s_barrier
    v_add_u32 v38, 0x20000, v46
    v_add_u32 v39, 0x20000, v47
    v_add_u32 v40, 0x20000, v48
    v_add_u32 v41, 0x20000, v49
    v_add_u32 v42, 0x20000, v50
    v_add_u32 v43, 0x20000, v51
    v_add_u32 v44, 0x20000, v52
    ds_read_b64_tr_b16 a[96:97], v38 offset:0
    ds_read_b64_tr_b16 a[98:99], v38 offset:8192
    ds_read_b64_tr_b16 a[100:101], v39 offset:0
    ds_read_b64_tr_b16 a[102:103], v39 offset:8192
    ds_read_b64_tr_b16 a[104:105], v40 offset:0
    ds_read_b64_tr_b16 a[106:107], v40 offset:8192
    ds_read_b64_tr_b16 a[108:109], v41 offset:0
    ds_read_b64_tr_b16 a[110:111], v41 offset:8192
    s_waitcnt lgkmcnt(10)
    v_mfma_f32_32x32x16_bf16 v[208:223], a[88:91], a[220:223], v[208:223]
    ds_read_b64_tr_b16 a[112:113], v42 offset:0
    ds_read_b64_tr_b16 a[114:115], v42 offset:8192
    s_waitcnt lgkmcnt(10)
    v_mfma_f32_32x32x16_bf16 v[224:239], a[92:95], a[220:223], v[224:239]
    ds_read_b64_tr_b16 a[116:117], v43 offset:0
    ds_read_b64_tr_b16 a[118:119], v43 offset:8192
    s_waitcnt lgkmcnt(10)
    v_mfma_f32_32x32x16_bf16 v[128:143], a[96:99], a[224:227], v[128:143]
    ds_read_b64_tr_b16 a[120:121], v44 offset:0
    ds_read_b64_tr_b16 a[122:123], v44 offset:8192
    s_waitcnt lgkmcnt(10)
    v_mfma_f32_32x32x16_bf16 v[144:159], a[100:103], a[224:227], v[144:159]
    ds_read_b64_tr_b16 a[124:125], v38 offset:16384
    ds_read_b64_tr_b16 a[126:127], v38 offset:24576
    s_waitcnt lgkmcnt(10)
    v_mfma_f32_32x32x16_bf16 v[160:175], a[104:107], a[224:227], v[160:175]
    ds_read_b64_tr_b16 a[64:65], v39 offset:16384
    ds_read_b64_tr_b16 a[66:67], v39 offset:24576
    s_waitcnt lgkmcnt(10)
    v_mfma_f32_32x32x16_bf16 v[176:191], a[108:111], a[224:227], v[176:191]
    ds_read_b64_tr_b16 a[68:69], v40 offset:16384
    ds_read_b64_tr_b16 a[70:71], v40 offset:24576
    s_waitcnt lgkmcnt(10)
    v_mfma_f32_32x32x16_bf16 v[192:207], a[112:115], a[224:227], v[192:207]
    ds_read_b64_tr_b16 a[72:73], v41 offset:16384
    ds_read_b64_tr_b16 a[74:75], v41 offset:24576
    s_waitcnt lgkmcnt(10)
    v_mfma_f32_32x32x16_bf16 v[208:223], a[116:119], a[224:227], v[208:223]
    ds_read_b64_tr_b16 a[76:77], v42 offset:16384
    ds_read_b64_tr_b16 a[78:79], v42 offset:24576
    s_waitcnt lgkmcnt(10)
    v_mfma_f32_32x32x16_bf16 v[224:239], a[120:123], a[224:227], v[224:239]
    ds_read_b64_tr_b16 a[80:81], v43 offset:16384
    ds_read_b64_tr_b16 a[82:83], v43 offset:24576
    s_waitcnt lgkmcnt(10)
    v_mfma_f32_32x32x16_bf16 v[128:143], a[124:127], a[228:231], v[128:143]
    ds_read_b64_tr_b16 a[84:85], v44 offset:16384
    ds_read_b64_tr_b16 a[86:87], v44 offset:24576
    s_waitcnt lgkmcnt(10)
    v_mfma_f32_32x32x16_bf16 v[144:159], a[64:67], a[228:231], v[144:159]
    s_waitcnt lgkmcnt(8)
    v_mfma_f32_32x32x16_bf16 v[160:175], a[68:71], a[228:231], v[160:175]
    s_waitcnt lgkmcnt(6)
    v_mfma_f32_32x32x16_bf16 v[176:191], a[72:75], a[228:231], v[176:191]
    s_waitcnt lgkmcnt(4)
    v_mfma_f32_32x32x16_bf16 v[192:207], a[76:79], a[228:231], v[192:207]
    s_waitcnt lgkmcnt(0)
    s_waitcnt vmcnt(16)
    s_barrier
    v_add_u32 v96, 0x0, v46
    v_add_u32 v97, 0x0, v47
    v_add_u32 v98, 0x0, v48
    v_add_u32 v99, 0x0, v49
    v_add_u32 v100, 0x0, v50
    v_add_u32 v101, 0x0, v51
    v_add_u32 v102, 0x0, v52
    ds_read_b64_tr_b16 a[88:89], v96 offset:0
    ds_read_b64_tr_b16 a[90:91], v96 offset:8192
    ds_read_b64_tr_b16 a[92:93], v97 offset:0
    ds_read_b64_tr_b16 a[94:95], v97 offset:8192
    ds_read_b64_tr_b16 a[96:97], v98 offset:0
    ds_read_b64_tr_b16 a[98:99], v98 offset:8192
    ds_read_b64_tr_b16 a[100:101], v99 offset:0
    ds_read_b64_tr_b16 a[102:103], v99 offset:8192
    s_waitcnt lgkmcnt(10)
    v_mfma_f32_32x32x16_bf16 v[208:223], a[80:83], a[228:231], v[208:223]
    ds_read_b64_tr_b16 a[104:105], v100 offset:0
    ds_read_b64_tr_b16 a[106:107], v100 offset:8192
    s_waitcnt lgkmcnt(10)
    v_mfma_f32_32x32x16_bf16 v[224:239], a[84:87], a[228:231], v[224:239]
    ds_read_b64_tr_b16 a[108:109], v101 offset:0
    ds_read_b64_tr_b16 a[110:111], v101 offset:8192
    s_waitcnt lgkmcnt(10)
    v_mfma_f32_32x32x16_bf16 v[128:143], a[88:91], a[232:235], v[128:143]
    ds_read_b64_tr_b16 a[112:113], v102 offset:0
    ds_read_b64_tr_b16 a[114:115], v102 offset:8192
    s_waitcnt lgkmcnt(10)
    v_mfma_f32_32x32x16_bf16 v[144:159], a[92:95], a[232:235], v[144:159]
    ds_read_b64_tr_b16 a[116:117], v96 offset:16384
    ds_read_b64_tr_b16 a[118:119], v96 offset:24576
    s_waitcnt lgkmcnt(10)
    v_mfma_f32_32x32x16_bf16 v[160:175], a[96:99], a[232:235], v[160:175]
    ds_read_b64_tr_b16 a[120:121], v97 offset:16384
    ds_read_b64_tr_b16 a[122:123], v97 offset:24576
    s_waitcnt lgkmcnt(10)
    v_mfma_f32_32x32x16_bf16 v[176:191], a[100:103], a[232:235], v[176:191]
    ds_read_b64_tr_b16 a[124:125], v98 offset:16384
    ds_read_b64_tr_b16 a[126:127], v98 offset:24576
    s_waitcnt lgkmcnt(10)
    v_mfma_f32_32x32x16_bf16 v[192:207], a[104:107], a[232:235], v[192:207]
    ds_read_b64_tr_b16 a[64:65], v99 offset:16384
    ds_read_b64_tr_b16 a[66:67], v99 offset:24576
    s_waitcnt lgkmcnt(10)
    v_mfma_f32_32x32x16_bf16 v[208:223], a[108:111], a[232:235], v[208:223]
    ds_read_b64_tr_b16 a[68:69], v100 offset:16384
    ds_read_b64_tr_b16 a[70:71], v100 offset:24576
    s_waitcnt lgkmcnt(10)
    v_mfma_f32_32x32x16_bf16 v[224:239], a[112:115], a[232:235], v[224:239]
    ds_read_b64_tr_b16 a[72:73], v101 offset:16384
    ds_read_b64_tr_b16 a[74:75], v101 offset:24576
    s_waitcnt lgkmcnt(10)
    v_mfma_f32_32x32x16_bf16 v[128:143], a[116:119], a[236:239], v[128:143]
    ds_read_b64_tr_b16 a[76:77], v102 offset:16384
    ds_read_b64_tr_b16 a[78:79], v102 offset:24576
    s_waitcnt lgkmcnt(10)
    v_mfma_f32_32x32x16_bf16 v[144:159], a[120:123], a[236:239], v[144:159]
    s_waitcnt lgkmcnt(8)
    v_mfma_f32_32x32x16_bf16 v[160:175], a[124:127], a[236:239], v[160:175]
    s_waitcnt lgkmcnt(6)
    v_mfma_f32_32x32x16_bf16 v[176:191], a[64:67], a[236:239], v[176:191]
    s_waitcnt lgkmcnt(4)
    v_mfma_f32_32x32x16_bf16 v[192:207], a[68:71], a[236:239], v[192:207]
    s_waitcnt lgkmcnt(0)
    s_waitcnt vmcnt(8)
    s_barrier
    v_add_u32 v38, 0x8000, v46
    v_add_u32 v39, 0x8000, v47
    v_add_u32 v40, 0x8000, v48
    v_add_u32 v41, 0x8000, v49
    v_add_u32 v42, 0x8000, v50
    v_add_u32 v43, 0x8000, v51
    v_add_u32 v44, 0x8000, v52
    ds_read_b64_tr_b16 a[80:81], v38 offset:0
    ds_read_b64_tr_b16 a[82:83], v38 offset:8192
    ds_read_b64_tr_b16 a[84:85], v39 offset:0
    ds_read_b64_tr_b16 a[86:87], v39 offset:8192
    ds_read_b64_tr_b16 a[88:89], v40 offset:0
    ds_read_b64_tr_b16 a[90:91], v40 offset:8192
    ds_read_b64_tr_b16 a[92:93], v41 offset:0
    ds_read_b64_tr_b16 a[94:95], v41 offset:8192
    s_waitcnt lgkmcnt(10)
    v_mfma_f32_32x32x16_bf16 v[208:223], a[72:75], a[236:239], v[208:223]
    ds_read_b64_tr_b16 a[96:97], v42 offset:0
    ds_read_b64_tr_b16 a[98:99], v42 offset:8192
    s_waitcnt lgkmcnt(10)
    v_mfma_f32_32x32x16_bf16 v[224:239], a[76:79], a[236:239], v[224:239]
    ds_read_b64_tr_b16 a[100:101], v43 offset:0
    ds_read_b64_tr_b16 a[102:103], v43 offset:8192
    s_waitcnt lgkmcnt(10)
    v_mfma_f32_32x32x16_bf16 v[128:143], a[80:83], a[240:243], v[128:143]
    ds_read_b64_tr_b16 a[104:105], v44 offset:0
    ds_read_b64_tr_b16 a[106:107], v44 offset:8192
    s_waitcnt lgkmcnt(10)
    v_mfma_f32_32x32x16_bf16 v[144:159], a[84:87], a[240:243], v[144:159]
    ds_read_b64_tr_b16 a[108:109], v38 offset:16384
    ds_read_b64_tr_b16 a[110:111], v38 offset:24576
    s_waitcnt lgkmcnt(10)
    v_mfma_f32_32x32x16_bf16 v[160:175], a[88:91], a[240:243], v[160:175]
    ds_read_b64_tr_b16 a[112:113], v39 offset:16384
    ds_read_b64_tr_b16 a[114:115], v39 offset:24576
    s_waitcnt lgkmcnt(10)
    v_mfma_f32_32x32x16_bf16 v[176:191], a[92:95], a[240:243], v[176:191]
    ds_read_b64_tr_b16 a[116:117], v40 offset:16384
    ds_read_b64_tr_b16 a[118:119], v40 offset:24576
    s_waitcnt lgkmcnt(10)
    v_mfma_f32_32x32x16_bf16 v[192:207], a[96:99], a[240:243], v[192:207]
    ds_read_b64_tr_b16 a[120:121], v41 offset:16384
    ds_read_b64_tr_b16 a[122:123], v41 offset:24576
    s_waitcnt lgkmcnt(10)
    v_mfma_f32_32x32x16_bf16 v[208:223], a[100:103], a[240:243], v[208:223]
    ds_read_b64_tr_b16 a[124:125], v42 offset:16384
    ds_read_b64_tr_b16 a[126:127], v42 offset:24576
    s_waitcnt lgkmcnt(10)
    v_mfma_f32_32x32x16_bf16 v[224:239], a[104:107], a[240:243], v[224:239]
    ds_read_b64_tr_b16 a[64:65], v43 offset:16384
    ds_read_b64_tr_b16 a[66:67], v43 offset:24576
    s_waitcnt lgkmcnt(10)
    v_mfma_f32_32x32x16_bf16 v[128:143], a[108:111], a[244:247], v[128:143]
    ds_read_b64_tr_b16 a[68:69], v44 offset:16384
    ds_read_b64_tr_b16 a[70:71], v44 offset:24576
    s_waitcnt lgkmcnt(10)
    v_mfma_f32_32x32x16_bf16 v[144:159], a[112:115], a[244:247], v[144:159]
    s_waitcnt lgkmcnt(8)
    v_mfma_f32_32x32x16_bf16 v[160:175], a[116:119], a[244:247], v[160:175]
    s_waitcnt lgkmcnt(6)
    v_mfma_f32_32x32x16_bf16 v[176:191], a[120:123], a[244:247], v[176:191]
    s_waitcnt lgkmcnt(4)
    v_mfma_f32_32x32x16_bf16 v[192:207], a[124:127], a[244:247], v[192:207]
    s_waitcnt lgkmcnt(0)
    s_waitcnt vmcnt(0)
    s_barrier
    v_add_u32 v96, 0x10000, v46
    v_add_u32 v97, 0x10000, v47
    v_add_u32 v98, 0x10000, v48
    v_add_u32 v99, 0x10000, v49
    v_add_u32 v100, 0x10000, v50
    v_add_u32 v101, 0x10000, v51
    v_add_u32 v102, 0x10000, v52
    ds_read_b64_tr_b16 a[72:73], v96 offset:0
    ds_read_b64_tr_b16 a[74:75], v96 offset:8192
    ds_read_b64_tr_b16 a[76:77], v96 offset:16384
    ds_read_b64_tr_b16 a[78:79], v96 offset:24576
    ds_read_b64_tr_b16 a[80:81], v97 offset:0
    ds_read_b64_tr_b16 a[82:83], v97 offset:8192
    ds_read_b64_tr_b16 a[84:85], v97 offset:16384
    ds_read_b64_tr_b16 a[86:87], v97 offset:24576
    s_waitcnt lgkmcnt(10)
    v_mfma_f32_32x32x16_bf16 v[208:223], a[64:67], a[244:247], v[208:223]
    ds_read_b64_tr_b16 a[88:89], v98 offset:0
    ds_read_b64_tr_b16 a[90:91], v98 offset:8192
    s_waitcnt lgkmcnt(10)
    v_mfma_f32_32x32x16_bf16 v[224:239], a[68:71], a[244:247], v[224:239]
    ds_read_b64_tr_b16 a[92:93], v98 offset:16384
    ds_read_b64_tr_b16 a[94:95], v98 offset:24576
    s_waitcnt lgkmcnt(10)
    v_mfma_f32_32x32x16_bf16 v[128:143], a[72:75], a[248:251], v[128:143]
    ds_read_b64_tr_b16 a[96:97], v99 offset:0
    ds_read_b64_tr_b16 a[98:99], v99 offset:8192
    s_waitcnt lgkmcnt(10)
    v_mfma_f32_32x32x16_bf16 v[128:143], a[76:79], a[252:255], v[128:143]
    ds_read_b64_tr_b16 a[100:101], v99 offset:16384
    ds_read_b64_tr_b16 a[102:103], v99 offset:24576
    s_waitcnt lgkmcnt(10)
    v_mfma_f32_32x32x16_bf16 v[144:159], a[80:83], a[248:251], v[144:159]
    ds_read_b64_tr_b16 a[104:105], v100 offset:0
    ds_read_b64_tr_b16 a[106:107], v100 offset:8192
    s_waitcnt lgkmcnt(10)
    v_mfma_f32_32x32x16_bf16 v[144:159], a[84:87], a[252:255], v[144:159]
    ds_read_b64_tr_b16 a[108:109], v100 offset:16384
    ds_read_b64_tr_b16 a[110:111], v100 offset:24576
    s_waitcnt lgkmcnt(10)
    v_mfma_f32_32x32x16_bf16 v[160:175], a[88:91], a[248:251], v[160:175]
    ds_read_b64_tr_b16 a[112:113], v101 offset:0
    ds_read_b64_tr_b16 a[114:115], v101 offset:8192
    s_waitcnt lgkmcnt(10)
    v_mfma_f32_32x32x16_bf16 v[160:175], a[92:95], a[252:255], v[160:175]
    ds_read_b64_tr_b16 a[116:117], v101 offset:16384
    ds_read_b64_tr_b16 a[118:119], v101 offset:24576
    s_waitcnt lgkmcnt(10)
    v_mfma_f32_32x32x16_bf16 v[176:191], a[96:99], a[248:251], v[176:191]
    ds_read_b64_tr_b16 a[120:121], v102 offset:0
    ds_read_b64_tr_b16 a[122:123], v102 offset:8192
    s_waitcnt lgkmcnt(10)
    v_mfma_f32_32x32x16_bf16 v[176:191], a[100:103], a[252:255], v[176:191]
    ds_read_b64_tr_b16 a[124:125], v102 offset:16384
    ds_read_b64_tr_b16 a[126:127], v102 offset:24576
    v_cvt_pk_bf16_f32 v128, v128, v129
    v_cvt_pk_bf16_f32 v129, v130, v131
    v_cvt_pk_bf16_f32 v130, v132, v133
    v_cvt_pk_bf16_f32 v131, v134, v135
    v_cvt_pk_bf16_f32 v132, v136, v137
    v_cvt_pk_bf16_f32 v133, v138, v139
    v_cvt_pk_bf16_f32 v134, v140, v141
    v_cvt_pk_bf16_f32 v135, v142, v143
    buffer_store_dwordx4 v[128:131], v1, s[28:31], s83 offen offset:0 sc1
    buffer_store_dwordx4 v[132:135], v1, s[28:31], s83 offen offset:1024 sc1
    s_waitcnt lgkmcnt(10)
    v_mfma_f32_32x32x16_bf16 v[192:207], a[104:107], a[248:251], v[192:207]
    s_waitcnt lgkmcnt(8)
    v_mfma_f32_32x32x16_bf16 v[192:207], a[108:111], a[252:255], v[192:207]
    v_cvt_pk_bf16_f32 v144, v144, v145
    v_cvt_pk_bf16_f32 v145, v146, v147
    v_cvt_pk_bf16_f32 v146, v148, v149
    v_cvt_pk_bf16_f32 v147, v150, v151
    v_cvt_pk_bf16_f32 v148, v152, v153
    v_cvt_pk_bf16_f32 v149, v154, v155
    v_cvt_pk_bf16_f32 v150, v156, v157
    v_cvt_pk_bf16_f32 v151, v158, v159
    buffer_store_dwordx4 v[144:147], v1, s[28:31], s83 offen offset:2048 sc1
    buffer_store_dwordx4 v[148:151], v1, s[28:31], s83 offen offset:3072 sc1
    s_waitcnt lgkmcnt(6)
    v_mfma_f32_32x32x16_bf16 v[208:223], a[112:115], a[248:251], v[208:223]
    s_waitcnt lgkmcnt(4)
    v_mfma_f32_32x32x16_bf16 v[208:223], a[116:119], a[252:255], v[208:223]
    v_cvt_pk_bf16_f32 v160, v160, v161
    v_cvt_pk_bf16_f32 v161, v162, v163
    v_cvt_pk_bf16_f32 v162, v164, v165
    v_cvt_pk_bf16_f32 v163, v166, v167
    v_cvt_pk_bf16_f32 v164, v168, v169
    v_cvt_pk_bf16_f32 v165, v170, v171
    v_cvt_pk_bf16_f32 v166, v172, v173
    v_cvt_pk_bf16_f32 v167, v174, v175
    s_add_u32 s83, s83, 0x1000
    buffer_store_dwordx4 v[160:163], v1, s[28:31], s83 offen offset:0 sc1
    buffer_store_dwordx4 v[164:167], v1, s[28:31], s83 offen offset:1024 sc1
    s_waitcnt lgkmcnt(2)
    v_mfma_f32_32x32x16_bf16 v[224:239], a[120:123], a[248:251], v[224:239]
    s_waitcnt lgkmcnt(0)
    v_mfma_f32_32x32x16_bf16 v[224:239], a[124:127], a[252:255], v[224:239]
    v_cvt_pk_bf16_f32 v176, v176, v177
    v_cvt_pk_bf16_f32 v177, v178, v179
    v_cvt_pk_bf16_f32 v178, v180, v181
    v_cvt_pk_bf16_f32 v179, v182, v183
    v_cvt_pk_bf16_f32 v180, v184, v185
    v_cvt_pk_bf16_f32 v181, v186, v187
    v_cvt_pk_bf16_f32 v182, v188, v189
    v_cvt_pk_bf16_f32 v183, v190, v191
    buffer_store_dwordx4 v[176:179], v1, s[28:31], s83 offen offset:2048 sc1
    buffer_store_dwordx4 v[180:183], v1, s[28:31], s83 offen offset:3072 sc1
    s_nop 15
    v_cvt_pk_bf16_f32 v192, v192, v193
    v_cvt_pk_bf16_f32 v193, v194, v195
    v_cvt_pk_bf16_f32 v194, v196, v197
    v_cvt_pk_bf16_f32 v195, v198, v199
    v_cvt_pk_bf16_f32 v196, v200, v201
    v_cvt_pk_bf16_f32 v197, v202, v203
    v_cvt_pk_bf16_f32 v198, v204, v205
    v_cvt_pk_bf16_f32 v199, v206, v207
    s_add_u32 s83, s83, 0x1000
    buffer_store_dwordx4 v[192:195], v1, s[28:31], s83 offen offset:0 sc1
    buffer_store_dwordx4 v[196:199], v1, s[28:31], s83 offen offset:1024 sc1
    v_cvt_pk_bf16_f32 v208, v208, v209
    v_cvt_pk_bf16_f32 v209, v210, v211
    v_cvt_pk_bf16_f32 v210, v212, v213
    v_cvt_pk_bf16_f32 v211, v214, v215
    v_cvt_pk_bf16_f32 v212, v216, v217
    v_cvt_pk_bf16_f32 v213, v218, v219
    v_cvt_pk_bf16_f32 v214, v220, v221
    v_cvt_pk_bf16_f32 v215, v222, v223
    buffer_store_dwordx4 v[208:211], v1, s[28:31], s83 offen offset:2048 sc1
    buffer_store_dwordx4 v[212:215], v1, s[28:31], s83 offen offset:3072 sc1
    v_cvt_pk_bf16_f32 v224, v224, v225
    v_cvt_pk_bf16_f32 v225, v226, v227
    v_cvt_pk_bf16_f32 v226, v228, v229
    v_cvt_pk_bf16_f32 v227, v230, v231
    v_cvt_pk_bf16_f32 v228, v232, v233
    v_cvt_pk_bf16_f32 v229, v234, v235
    v_cvt_pk_bf16_f32 v230, v236, v237
    v_cvt_pk_bf16_f32 v231, v238, v239
    s_add_u32 s83, s83, 0x1000
    buffer_store_dwordx4 v[224:227], v1, s[28:31], s83 offen offset:0 sc1
    buffer_store_dwordx4 v[228:231], v1, s[28:31], s83 offen offset:1024 sc1
L_attn_end:
    s_endpgm
    .p2align 8
reduce_kernel:
    s_cmp_ge_u32 s2, 448
    s_cbranch_scc1 L_red_end
    s_load_dwordx2 s[4:5], s[0:1], 80
    s_load_dwordx2 s[6:7], s[0:1], 96
    s_mul_i32 s16, s2, 4682
    s_lshr_b32 s16, s16, 16
    s_mul_i32 s17, s16, 14
    s_sub_u32 s17, s2, s17
    s_waitcnt lgkmcnt(0)
    s_mov_b32 s8, s4
    s_mov_b32 s9, s5
    s_mov_b32 s10, 1835008
    s_mov_b32 s11, 0x20000
    s_mov_b32 s12, s6
    s_mov_b32 s13, s7
    s_mov_b32 s14, 0xe00000
    s_mov_b32 s15, 0x20000
    s_mul_i32 s20, s16, 458752
    s_lshl_b32 s21, s17, 12
    s_add_u32 s20, s20, s21
    v_lshlrev_b32 v1, 4, v0
    buffer_load_dwordx4 v[8:11], v1, s[12:15], s20 offen
    s_add_u32 s20, s20, 57344
    buffer_load_dwordx4 v[12:15], v1, s[12:15], s20 offen
    s_add_u32 s20, s20, 57344
    buffer_load_dwordx4 v[16:19], v1, s[12:15], s20 offen
    s_add_u32 s20, s20, 57344
    buffer_load_dwordx4 v[20:23], v1, s[12:15], s20 offen
    s_add_u32 s20, s20, 57344
    buffer_load_dwordx4 v[24:27], v1, s[12:15], s20 offen
    s_add_u32 s20, s20, 57344
    buffer_load_dwordx4 v[28:31], v1, s[12:15], s20 offen
    s_add_u32 s20, s20, 57344
    buffer_load_dwordx4 v[32:35], v1, s[12:15], s20 offen
    s_add_u32 s20, s20, 57344
    buffer_load_dwordx4 v[36:39], v1, s[12:15], s20 offen
    v_lshrrev_b32 v4, 6, v0
    s_lshl_b32 s21, s17, 2
    v_add_u32 v4, s21, v4
    v_mul_u32_u24 v5, 4682, v4
    v_lshrrev_b32 v5, 16, v5
    v_mul_u32_u24 v6, 14, v5
    v_sub_u32 v6, v4, v6
    v_and_b32 v2, 31, v0
    v_bfe_u32 v3, v0, 5, 1
    s_and_b32 s22, s16, 15
    s_lshr_b32 s23, s16, 4
    s_lshl_b32 s22, s22, 6
    v_and_b32 v7, 1, v5
    v_lshl_add_u32 v2, v7, 5, v2
    v_add_u32 v2, s22, v2
    v_mul_u32_u24 v2, 896, v2
    s_mul_i32 s23, s23, 448
    v_add_u32 v2, s23, v2
    v_lshrrev_b32 v7, 1, v5
    v_mul_u32_u24 v7, 224, v7
    v_add_u32 v2, v7, v2
    v_lshl_add_u32 v2, v6, 4, v2
    v_lshl_add_u32 v2, v3, 2, v2
    v_lshlrev_b32 v2, 1, v2
    s_waitcnt vmcnt(7)
    v_lshlrev_b32 v40, 16, v8
    v_and_b32 v41, 0xffff0000, v8
    v_lshlrev_b32 v42, 16, v9
    v_and_b32 v43, 0xffff0000, v9
    v_lshlrev_b32 v44, 16, v10
    v_and_b32 v45, 0xffff0000, v10
    v_lshlrev_b32 v46, 16, v11
    v_and_b32 v47, 0xffff0000, v11
    s_waitcnt vmcnt(6)
    v_lshlrev_b32 v48, 16, v12
    v_and_b32 v49, 0xffff0000, v12
    v_add_f32 v40, v40, v48
    v_add_f32 v41, v41, v49
    v_lshlrev_b32 v48, 16, v13
    v_and_b32 v49, 0xffff0000, v13
    v_add_f32 v42, v42, v48
    v_add_f32 v43, v43, v49
    v_lshlrev_b32 v48, 16, v14
    v_and_b32 v49, 0xffff0000, v14
    v_add_f32 v44, v44, v48
    v_add_f32 v45, v45, v49
    v_lshlrev_b32 v48, 16, v15
    v_and_b32 v49, 0xffff0000, v15
    v_add_f32 v46, v46, v48
    v_add_f32 v47, v47, v49
    s_waitcnt vmcnt(5)
    v_lshlrev_b32 v48, 16, v16
    v_and_b32 v49, 0xffff0000, v16
    v_add_f32 v40, v40, v48
    v_add_f32 v41, v41, v49
    v_lshlrev_b32 v48, 16, v17
    v_and_b32 v49, 0xffff0000, v17
    v_add_f32 v42, v42, v48
    v_add_f32 v43, v43, v49
    v_lshlrev_b32 v48, 16, v18
    v_and_b32 v49, 0xffff0000, v18
    v_add_f32 v44, v44, v48
    v_add_f32 v45, v45, v49
    v_lshlrev_b32 v48, 16, v19
    v_and_b32 v49, 0xffff0000, v19
    v_add_f32 v46, v46, v48
    v_add_f32 v47, v47, v49
    s_waitcnt vmcnt(4)
    v_lshlrev_b32 v48, 16, v20
    v_and_b32 v49, 0xffff0000, v20
    v_add_f32 v40, v40, v48
    v_add_f32 v41, v41, v49
    v_lshlrev_b32 v48, 16, v21
    v_and_b32 v49, 0xffff0000, v21
    v_add_f32 v42, v42, v48
    v_add_f32 v43, v43, v49
    v_lshlrev_b32 v48, 16, v22
    v_and_b32 v49, 0xffff0000, v22
    v_add_f32 v44, v44, v48
    v_add_f32 v45, v45, v49
    v_lshlrev_b32 v48, 16, v23
    v_and_b32 v49, 0xffff0000, v23
    v_add_f32 v46, v46, v48
    v_add_f32 v47, v47, v49
    s_waitcnt vmcnt(3)
    v_lshlrev_b32 v48, 16, v24
    v_and_b32 v49, 0xffff0000, v24
    v_add_f32 v40, v40, v48
    v_add_f32 v41, v41, v49
    v_lshlrev_b32 v48, 16, v25
    v_and_b32 v49, 0xffff0000, v25
    v_add_f32 v42, v42, v48
    v_add_f32 v43, v43, v49
    v_lshlrev_b32 v48, 16, v26
    v_and_b32 v49, 0xffff0000, v26
    v_add_f32 v44, v44, v48
    v_add_f32 v45, v45, v49
    v_lshlrev_b32 v48, 16, v27
    v_and_b32 v49, 0xffff0000, v27
    v_add_f32 v46, v46, v48
    v_add_f32 v47, v47, v49
    s_waitcnt vmcnt(2)
    v_lshlrev_b32 v48, 16, v28
    v_and_b32 v49, 0xffff0000, v28
    v_add_f32 v40, v40, v48
    v_add_f32 v41, v41, v49
    v_lshlrev_b32 v48, 16, v29
    v_and_b32 v49, 0xffff0000, v29
    v_add_f32 v42, v42, v48
    v_add_f32 v43, v43, v49
    v_lshlrev_b32 v48, 16, v30
    v_and_b32 v49, 0xffff0000, v30
    v_add_f32 v44, v44, v48
    v_add_f32 v45, v45, v49
    v_lshlrev_b32 v48, 16, v31
    v_and_b32 v49, 0xffff0000, v31
    v_add_f32 v46, v46, v48
    v_add_f32 v47, v47, v49
    s_waitcnt vmcnt(1)
    v_lshlrev_b32 v48, 16, v32
    v_and_b32 v49, 0xffff0000, v32
    v_add_f32 v40, v40, v48
    v_add_f32 v41, v41, v49
    v_lshlrev_b32 v48, 16, v33
    v_and_b32 v49, 0xffff0000, v33
    v_add_f32 v42, v42, v48
    v_add_f32 v43, v43, v49
    v_lshlrev_b32 v48, 16, v34
    v_and_b32 v49, 0xffff0000, v34
    v_add_f32 v44, v44, v48
    v_add_f32 v45, v45, v49
    v_lshlrev_b32 v48, 16, v35
    v_and_b32 v49, 0xffff0000, v35
    v_add_f32 v46, v46, v48
    v_add_f32 v47, v47, v49
    s_waitcnt vmcnt(0)
    v_lshlrev_b32 v48, 16, v36
    v_and_b32 v49, 0xffff0000, v36
    v_add_f32 v40, v40, v48
    v_add_f32 v41, v41, v49
    v_lshlrev_b32 v48, 16, v37
    v_and_b32 v49, 0xffff0000, v37
    v_add_f32 v42, v42, v48
    v_add_f32 v43, v43, v49
    v_lshlrev_b32 v48, 16, v38
    v_and_b32 v49, 0xffff0000, v38
    v_add_f32 v44, v44, v48
    v_add_f32 v45, v45, v49
    v_lshlrev_b32 v48, 16, v39
    v_and_b32 v49, 0xffff0000, v39
    v_add_f32 v46, v46, v48
    v_add_f32 v47, v47, v49
    v_cvt_pk_bf16_f32 v8, v40, v41
    v_cvt_pk_bf16_f32 v9, v42, v43
    v_cvt_pk_bf16_f32 v10, v44, v45
    v_cvt_pk_bf16_f32 v11, v46, v47
    buffer_store_dwordx2 v[8:9], v2, s[8:11], 0 offen
    buffer_store_dwordx2 v[10:11], v2, s[8:11], 0 offen offset:16
L_red_end:
    s_endpgm
.section .rodata,"a"
.p2align 6
.amdhsa_kernel attn_kernel
  .amdhsa_next_free_vgpr 512
  .amdhsa_next_free_sgpr 102
  .amdhsa_accum_offset 256
  .amdhsa_group_segment_fixed_size 0
  .amdhsa_kernarg_size 104
  .amdhsa_user_sgpr_count 2
  .amdhsa_user_sgpr_kernarg_segment_ptr 1
  .amdhsa_system_sgpr_workgroup_id_x 1
.end_amdhsa_kernel
.p2align 6
.amdhsa_kernel reduce_kernel
  .amdhsa_next_free_vgpr 56
  .amdhsa_next_free_sgpr 32
  .amdhsa_accum_offset 56
  .amdhsa_group_segment_fixed_size 0
  .amdhsa_kernarg_size 104
  .amdhsa_user_sgpr_count 2
  .amdhsa_user_sgpr_kernarg_segment_ptr 1
  .amdhsa_system_sgpr_workgroup_id_x 1
.end_amdhsa_kernel
```
